```python
import torch

def _softmax(x, axis=-1):
    return torch.softmax(x, dim=axis)
def _gelu(x):
    return torch.nn.functional.gelu(x, approximate="tanh")
def _silu(x):
    return torch.nn.functional.silu(x)
def _sigmoid(x):
    return torch.sigmoid(x)
def _layernorm(x, axis=-1, eps=1e-5):
    m = x.mean(dim=axis, keepdim=True)
    v = x.var(dim=axis, keepdim=True, unbiased=False)
    return (x - m) / torch.sqrt(v + eps)
def _scatter_add(tgt, idx, src, axis=0):
    return tgt.clone().index_add_(axis, idx, src)
def _segment_sum(src, seg, n):
    out = torch.zeros((n,) + src.shape[1:], dtype=src.dtype)
    return out.index_add_(0, seg, src)
def _pad(x, pw):
    flat = tuple(v for pair in reversed(pw) for v in pair)
    return torch.nn.functional.pad(x, flat)

kernel_name = 'sequential_preLN__linear_attn_block__mixer_s_mlp__prompt'

def setup_inputs():

    _w = (lambda a: (lambda t: t.to(torch.bfloat16) if t.is_floating_point() else t)(torch.as_tensor(a)))
    def _A_setup():
        B, S, D = 1, 2048, 576
        return {
            "x": _w((lambda *s: torch.randn(*s, dtype=torch.bfloat16) * 0.05)(B, S, D)),
            "wqkv": _w((lambda *s: torch.randn(*s, dtype=torch.bfloat16) * 0.05)(D, 3 * D)),
            "wo": _w((lambda *s: torch.randn(*s, dtype=torch.bfloat16) * 0.05)(D, D)),
        }
    _A_in = _A_setup()

    def _B_setup():
        B, S, D, F = 1, 2048, 576, 4608
        return {
            "x":  _w((lambda *s: torch.randn(*s, dtype=torch.bfloat16) * 0.05)(B, S, D)),
            "w1": _w((lambda *s: torch.randn(*s, dtype=torch.bfloat16) * 3.2)(D, D) * (D ** -0.5)),
            "w2": _w((lambda *s: torch.randn(*s, dtype=torch.bfloat16) * 3.2)(D, D) * (D ** -0.5)),
            "w3": _w((lambda *s: torch.randn(*s, dtype=torch.bfloat16) * 3.2)(D, F) * (D ** -0.5)),
            "w4": _w((lambda *s: torch.randn(*s, dtype=torch.bfloat16) * 1.6)(F, D) * (F ** -0.5)),
        }
    _B_in = _B_setup()

    return {
        "A_x": _A_in["x"],
        "A_wqkv": _A_in["wqkv"],
        "A_wo": _A_in["wo"],
        "B_x": _B_in["x"],
        "B_w1": _B_in["w1"],
        "B_w2": _B_in["w2"],
        "B_w3": _B_in["w3"],
        "B_w4": _B_in["w4"],
    }

def reference(A_x, A_wqkv, A_wo, B_x, B_w1, B_w2, B_w3, B_w4):
    def _A_ref(x, wqkv, wo):
        B, S, D = x.shape
        H = 32; Dh = D // H
        qkv = (lambda x, *d: x.permute(*d))((x @ wqkv).reshape(B, S, 3, H, Dh), 2, 0, 3, 1, 4)
        q, k, v = qkv[0], qkv[1], qkv[2]
        phi = lambda t: torch.where(t > 0, t + 1, torch.exp(t)) + 1e-6
        pq, pk = phi(q), phi(k)
        kv = torch.einsum("bhsd,bhse->bhde", pk, v)
        z = torch.einsum("bhsd->bhd", pk)
        num = torch.einsum("bhqd,bhde->bhqe", pq, kv)
        den = torch.einsum("bhqd,bhd->bhq", pq, z)[..., None] + 1e-6
        o = num / den
        return (lambda x, *d: x.permute(*d))(o, 0, 2, 1, 3).reshape(B, S, D) @ wo

    def _B_ref(x, w1, w2, w3, w4):
        B, S, D = x.shape
        h = _gelu(_layernorm(x, axis=-1) @ w1)
        c = D // 4
        g0 = _pad(h[:, :, 0*c:1*c], ((0, 0), (1, 0), (0, 0)))[:, :S, :]
        g1 = _pad(h[:, :, 1*c:2*c], ((0, 0), (0, 1), (0, 0)))[:, 1:, :]
        g2 = _pad(h[:, :, 2*c:3*c], ((0, 0), (2, 0), (0, 0)))[:, :S, :]
        g3 = _pad(h[:, :, 3*c:   ], ((0, 0), (0, 2), (0, 0)))[:, 2:, :]
        hs = torch.concatenate([g0, g1, g2, g3], axis=-1) @ w2
        x1 = x + hs
        h2 = _gelu(_layernorm(x1, axis=-1) @ w3) @ w4
        return x1 + h2

    x = A_x
    h = x + _A_ref(_layernorm(x, axis=-1), A_wqkv, A_wo)
    h2 = h + _B_ref(_layernorm(h, axis=-1), B_w1, B_w2, B_w3, B_w4)
    return h2
```

```asm
; @launch grid=(256,1,1) block=(768,1,1) lds=163840
.amdgcn_target "amdgcn-amd-amdhsa--gfx950"
.text
.globl sequential_preLN__linear_attn_block__mixer_s_mlp__prompt_kernel
.p2align 8
.type sequential_preLN__linear_attn_block__mixer_s_mlp__prompt_kernel,@function
sequential_preLN__linear_attn_block__mixer_s_mlp__prompt_kernel:
    s_cmp_ge_u32 s2, 256
    s_cbranch_scc1 L_exit
    s_load_dwordx4 s[4:7], s[0:1], 0
    s_load_dwordx2 s[32:33], s[0:1], 64
    s_load_dwordx2 s[34:35], s[0:1], 80
    v_lshrrev_b32 v2, 6, v0
    v_and_b32 v1, 63, v0
    v_readfirstlane_b32 s3, v2
    s_and_b32 s29, s2, 7
    s_lshr_b32 s30, s2, 3
    s_mov_b32 s64, 0xffff
    s_mov_b32 s65, 0
    s_mov_b32 s66, 0xffff0000
    s_mov_b32 s67, 0
    s_mov_b32 s68, 0
    s_mov_b32 s69, 0xffff
    s_mov_b32 s70, 0
    s_mov_b32 s71, 0xffff0000
    s_waitcnt lgkmcnt(0)
    s_mov_b32 s8, s4
    s_mov_b32 s9, s5
    s_mov_b32 s10, 0x240000
    s_mov_b32 s11, 0x20000
    s_mov_b32 s12, s6
    s_mov_b32 s13, s7
    s_mov_b32 s14, 0x1e6000
    s_mov_b32 s15, 0x20000
    s_mov_b32 s16, s34
    s_mov_b32 s17, s35
    s_mov_b32 s18, 0x4000000
    s_mov_b32 s19, 0x20000
    s_mov_b32 s20, s32
    s_mov_b32 s21, s33
    s_mov_b32 s22, 0x240000
    s_mov_b32 s23, 0x20000
    s_load_dword s28, s[34:35], 0
    s_and_b32 s48, s29, 1
    s_lshl_b32 s48, s48, 2
    s_and_b32 s31, s30, 3
    s_add_u32 s48, s48, s31
    s_lshr_b32 s49, s29, 1
    s_lshl_b32 s49, s49, 3
    s_lshr_b32 s31, s30, 2
    s_add_u32 s49, s49, s31
    s_cmp_ge_u32 s3, 8
    s_cbranch_scc1 L_p0_help
    v_mov_b32 v24, 0
    v_mov_b32 v25, 0
    v_mov_b32 v26, 0
    v_mov_b32 v27, 0
    s_lshl_b32 s31, s2, 3
    s_add_u32 s31, s31, s3
    s_mul_i32 s31, s31, 1152
    v_lshlrev_b32 v3, 4, v1
    buffer_load_dwordx4 v[20:23], v3, s[8:11], s31 offen
    s_mov_b64 exec, 0xff
    buffer_load_dwordx4 v[24:27], v3, s[8:11], s31 offen offset:1024
    s_mov_b64 exec, -1
    v_mov_b32 v12, 0
    v_mov_b32 v13, 0
    v_mov_b32 v14, 0
    v_mov_b32 v15, 0
    s_mov_b32 s32, 0x3f803f80
    s_waitcnt vmcnt(0)
    v_dot2_f32_bf16 v12, v20, s32, v12
    v_dot2_f32_bf16 v14, v20, v20, v14
    v_dot2_f32_bf16 v13, v21, s32, v13
    v_dot2_f32_bf16 v15, v21, v21, v15
    v_dot2_f32_bf16 v12, v22, s32, v12
    v_dot2_f32_bf16 v14, v22, v22, v14
    v_dot2_f32_bf16 v13, v23, s32, v13
    v_dot2_f32_bf16 v15, v23, v23, v15
    v_dot2_f32_bf16 v12, v24, s32, v12
    v_dot2_f32_bf16 v14, v24, v24, v14
    v_dot2_f32_bf16 v13, v25, s32, v13
    v_dot2_f32_bf16 v15, v25, v25, v15
    v_dot2_f32_bf16 v12, v26, s32, v12
    v_dot2_f32_bf16 v14, v26, v26, v14
    v_dot2_f32_bf16 v13, v27, s32, v13
    v_dot2_f32_bf16 v15, v27, v27, v15
    s_nop 1
    v_add_f32 v12, v12, v13
    s_nop 1
    v_add_f32 v13, v14, v15
    s_nop 0
    v_add_f32_dpp v12, v12, v12 quad_perm:[1,0,3,2] row_mask:0xf bank_mask:0xf
    s_nop 0
    v_add_f32_dpp v13, v13, v13 quad_perm:[1,0,3,2] row_mask:0xf bank_mask:0xf
    s_nop 0
    v_add_f32_dpp v12, v12, v12 quad_perm:[2,3,0,1] row_mask:0xf bank_mask:0xf
    s_nop 0
    v_add_f32_dpp v13, v13, v13 quad_perm:[2,3,0,1] row_mask:0xf bank_mask:0xf
    s_nop 0
    v_add_f32_dpp v12, v12, v12 row_half_mirror row_mask:0xf bank_mask:0xf
    s_nop 0
    v_add_f32_dpp v13, v13, v13 row_half_mirror row_mask:0xf bank_mask:0xf
    s_nop 0
    v_add_f32_dpp v12, v12, v12 row_mirror row_mask:0xf bank_mask:0xf
    s_nop 0
    v_add_f32_dpp v13, v13, v13 row_mirror row_mask:0xf bank_mask:0xf
    v_mov_b32 v14, v12
    v_mov_b32 v15, v13
    s_nop 0
    v_permlane16_swap_b32 v12, v14
    s_nop 0
    v_permlane16_swap_b32 v13, v15
    v_add_f32 v12, v12, v14
    v_add_f32 v13, v13, v15
    v_mov_b32 v14, v12
    v_mov_b32 v15, v13
    s_nop 0
    v_permlane32_swap_b32 v12, v14
    s_nop 0
    v_permlane32_swap_b32 v13, v15
    v_add_f32 v12, v12, v14
    v_add_f32 v13, v13, v15
    v_mul_f32 v12, 0x3ae38e39, v12
    v_mul_f32 v13, 0x3ae38e39, v13
    v_fma_f32 v13, -v12, v12, v13
    v_max_f32 v13, 0, v13
    v_add_f32 v13, 0x3727c5ac, v13
    v_rsq_f32 v14, v13
    s_nop 0
    v_mul_f32 v16, v12, v14
    v_sub_f32 v16, 0, v16
    v_mov_b32 v15, v14
    v_mov_b32 v17, v16
    v_lshlrev_b32 v148, 16, v20
    v_and_b32 v149, 0xffff0000, v20
    v_lshlrev_b32 v150, 16, v21
    v_and_b32 v151, 0xffff0000, v21
    v_lshlrev_b32 v152, 16, v22
    v_and_b32 v153, 0xffff0000, v22
    v_lshlrev_b32 v154, 16, v23
    v_and_b32 v155, 0xffff0000, v23
    v_pk_fma_f32 v[148:149], v[148:149], v[14:15], v[16:17]
    v_pk_fma_f32 v[150:151], v[150:151], v[14:15], v[16:17]
    v_pk_fma_f32 v[152:153], v[152:153], v[14:15], v[16:17]
    v_pk_fma_f32 v[154:155], v[154:155], v[14:15], v[16:17]
    v_cvt_pk_bf16_f32 v20, v148, v149
    v_cvt_pk_bf16_f32 v21, v150, v151
    v_cvt_pk_bf16_f32 v22, v152, v153
    v_cvt_pk_bf16_f32 v23, v154, v155
    v_lshlrev_b32 v148, 16, v24
    v_and_b32 v149, 0xffff0000, v24
    v_lshlrev_b32 v150, 16, v25
    v_and_b32 v151, 0xffff0000, v25
    v_lshlrev_b32 v152, 16, v26
    v_and_b32 v153, 0xffff0000, v26
    v_lshlrev_b32 v154, 16, v27
    v_and_b32 v155, 0xffff0000, v27
    v_pk_fma_f32 v[148:149], v[148:149], v[14:15], v[16:17]
    v_pk_fma_f32 v[150:151], v[150:151], v[14:15], v[16:17]
    v_pk_fma_f32 v[152:153], v[152:153], v[14:15], v[16:17]
    v_pk_fma_f32 v[154:155], v[154:155], v[14:15], v[16:17]
    v_cvt_pk_bf16_f32 v24, v148, v149
    v_cvt_pk_bf16_f32 v25, v150, v151
    v_cvt_pk_bf16_f32 v26, v152, v153
    v_cvt_pk_bf16_f32 v27, v154, v155
    s_add_u32 s31, s31, 0x1960000
    buffer_store_dwordx4 v[20:23], v3, s[16:19], s31 offen sc1
    s_mov_b64 exec, 0xff
    buffer_store_dwordx4 v[24:27], v3, s[16:19], s31 offen offset:1024 sc1
    s_mov_b64 exec, -1
    s_waitcnt vmcnt(0) lgkmcnt(0)
    s_mul_i32 s28, s28, 1664525
    s_add_u32 s28, s28, 1013904223
    s_barrier
    s_cmp_eq_u32 s3, 0
    s_cbranch_scc0 L_p0_nf
    s_lshl_b32 s31, s2, 7
    s_mov_b64 exec, 1
    v_mov_b32 v2, s28
    v_mov_b32 v3, 0x72000
    buffer_store_dword v2, v3, s[16:19], s31 offen sc1
    s_mov_b64 exec, -1
    s_lshl_b32 s31, s49, 10
    s_add_u32 s31, s31, 0x72000
    v_lshlrev_b32 v12, 7, v1
    v_add_u32 v12, s31, v12
    s_mov_b32 exec_lo, 0xff
    s_mov_b32 exec_hi, 0x0
    s_mov_b32 s72, 0x40000
Lpoll_1:
    buffer_load_dword v13, v12, s[16:19], 0 offen sc1
    s_waitcnt vmcnt(0)
    v_cmp_ne_u32 vcc, s28, v13
    s_cbranch_vccz Lpolld_2
    s_sub_u32 s72, s72, 1
    s_cbranch_scc1 Lpolld_2
    s_sleep 2
    s_branch Lpoll_1
Lpolld_2:
    s_mov_b64 exec, -1
L_p0_nf:
    s_barrier
    s_cmp_ge_u32 s3, 4
    s_cbranch_scc1 L_p1_q
    s_mov_b32 s44, s3
    s_lshl_b32 s31, s48, 2
    s_add_u32 s31, s31, s44
    s_mul_i32 s45, s31, 73728
    s_add_u32 s45, s45, 0x1720000
    v_lshlrev_b32 v3, 4, v1
    v_and_b32 v12, 15, v1
    v_lshrrev_b32 v13, 4, v1
    v_and_b32 v14, 7, v12
    v_mul_u32_u24 v15, 1152, v12
    v_xor_b32 v16, v13, v14
    v_lshl_add_u32 v8, v16, 4, v15
    v_or_b32 v16, 4, v13
    v_xor_b32 v16, v16, v14
    v_lshl_add_u32 v9, v16, 4, v15
    s_lshl_b32 s31, s3, 6
    v_add_u32 v12, s31, v1
    v_mul_u32_u24 v13, 911, v12
    v_lshrrev_b32 v13, 16, v13
    v_mul_u32_u24 v14, 72, v13
    v_sub_u32 v14, v12, v14
    v_xor_b32 v14, v14, v13
    v_mul_u32_u24 v13, 1152, v13
    v_lshl_add_u32 v4, v14, 4, v13
    s_mul_i32 s33, s49, 73728
    s_add_u32 s33, s33, 0x1960000
    s_lshl_b32 s31, s3, 10
    s_mov_b32 m0, s31
    s_add_u32 s31, s31, 9216
    buffer_load_dwordx4 v4, s[16:19], s33 offen sc1 lds
    s_add_u32 s33, s33, 9216
    s_mov_b32 m0, s31
    s_add_u32 s31, s31, 9216
    buffer_load_dwordx4 v4, s[16:19], s33 offen sc1 lds
    s_add_u32 s33, s33, 9216
    s_mov_b32 m0, s31
    s_add_u32 s31, s31, 9216
    buffer_load_dwordx4 v4, s[16:19], s33 offen sc1 lds
    s_add_u32 s33, s33, 9216
    s_mov_b32 m0, s31
    s_add_u32 s31, s31, 9216
    buffer_load_dwordx4 v4, s[16:19], s33 offen sc1 lds
    s_add_u32 s33, s33, 9216
    s_mov_b32 m0, s31
    s_add_u32 s31, s31, 9216
    buffer_load_dwordx4 v4, s[16:19], s33 offen sc1 lds
    s_add_u32 s33, s33, 9216
    s_mov_b32 m0, s31
    s_add_u32 s31, s31, 9216
    buffer_load_dwordx4 v4, s[16:19], s33 offen sc1 lds
    s_add_u32 s33, s33, 9216
    s_mov_b32 m0, s31
    s_add_u32 s31, s31, 9216
    buffer_load_dwordx4 v4, s[16:19], s33 offen sc1 lds
    s_add_u32 s33, s33, 9216
    s_mov_b32 m0, s31
    s_add_u32 s31, s31, 9216
    buffer_load_dwordx4 v4, s[16:19], s33 offen sc1 lds
    s_add_u32 s33, s33, 9216
    s_cmp_eq_u32 s3, 0
    s_cbranch_scc0 Lp1w_3
    s_mul_i32 s31, s48, 18
    s_add_u32 s33, s48, 230
    v_add_u32 v12, s31, v1
    v_add_u32 v13, s33, v1
    v_cmp_lt_u32 vcc, 17, v1
    s_nop 1
    v_cndmask_b32 v12, v12, v13, vcc
    v_lshlrev_b32 v12, 7, v12
    v_add_u32 v12, 0x8000, v12
    s_mov_b32 exec_lo, 0x7ffff
    s_mov_b32 exec_hi, 0x0
    s_mov_b32 s72, 0x40000
Lpoll_4:
    buffer_load_dword v13, v12, s[16:19], 0 offen sc1
    s_waitcnt vmcnt(0)
    v_cmp_ne_u32 vcc, s28, v13
    s_cbranch_vccz Lpolld_5
    s_sub_u32 s72, s72, 1
    s_cbranch_scc1 Lpolld_5
    s_sleep 2
    s_branch Lpoll_4
Lpolld_5:
    s_mov_b64 exec, -1
Lp1w_3:
    s_barrier
    buffer_load_dwordx4 v[84:87], v3, s[16:19], s45 offen offset:0 sc1
    buffer_load_dwordx4 v[88:91], v3, s[16:19], s45 offen offset:1024 sc1
    s_add_u32 s45, s45, 4096
    buffer_load_dwordx4 v[92:95], v3, s[16:19], s45 offen offset:0 sc1
    buffer_load_dwordx4 v[96:99], v3, s[16:19], s45 offen offset:1024 sc1
    s_add_u32 s45, s45, 4096
    buffer_load_dwordx4 v[100:103], v3, s[16:19], s45 offen offset:0 sc1
    buffer_load_dwordx4 v[104:107], v3, s[16:19], s45 offen offset:1024 sc1
    s_add_u32 s45, s45, 4096
    buffer_load_dwordx4 v[108:111], v3, s[16:19], s45 offen offset:0 sc1
    buffer_load_dwordx4 v[112:115], v3, s[16:19], s45 offen offset:1024 sc1
    s_add_u32 s45, s45, 4096
    buffer_load_dwordx4 v[116:119], v3, s[16:19], s45 offen offset:0 sc1
    buffer_load_dwordx4 v[120:123], v3, s[16:19], s45 offen offset:1024 sc1
    s_add_u32 s45, s45, 4096
    buffer_load_dwordx4 v[124:127], v3, s[16:19], s45 offen offset:0 sc1
    buffer_load_dwordx4 v[128:131], v3, s[16:19], s45 offen offset:1024 sc1
    s_add_u32 s45, s45, 4096
    v_mov_b32 v52, 0
    v_mov_b32 v53, 0
    v_mov_b32 v54, 0
    v_mov_b32 v55, 0
    v_mov_b32 v56, 0
    v_mov_b32 v57, 0
    v_mov_b32 v58, 0
    v_mov_b32 v59, 0
    v_mov_b32 v60, 0
    v_mov_b32 v61, 0
    v_mov_b32 v62, 0
    v_mov_b32 v63, 0
    v_mov_b32 v64, 0
    v_mov_b32 v65, 0
    v_mov_b32 v66, 0
    v_mov_b32 v67, 0
    v_mov_b32 v68, 0
    v_mov_b32 v69, 0
    v_mov_b32 v70, 0
    v_mov_b32 v71, 0
    v_mov_b32 v72, 0
    v_mov_b32 v73, 0
    v_mov_b32 v74, 0
    v_mov_b32 v75, 0
    v_mov_b32 v76, 0
    v_mov_b32 v77, 0
    v_mov_b32 v78, 0
    v_mov_b32 v79, 0
    v_mov_b32 v80, 0
    v_mov_b32 v81, 0
    v_mov_b32 v82, 0
    v_mov_b32 v83, 0
    s_waitcnt vmcnt(12)
    s_barrier
    ds_read_b128 v[20:23], v8 offset:0
    ds_read_b128 v[24:27], v8 offset:18432
    ds_read_b128 v[28:31], v8 offset:36864
    ds_read_b128 v[32:35], v8 offset:55296
    s_mov_b32 s47, 2
Lk_6:
    s_waitcnt vmcnt(10) lgkmcnt(0)
    v_mfma_f32_16x16x32_bf16 v[52:55], v[20:23], v[84:87], v[52:55]
    ds_read_b128 v[36:39], v9 offset:0
    v_mfma_f32_16x16x32_bf16 v[68:71], v[20:23], v[88:91], v[68:71]
    ds_read_b128 v[40:43], v9 offset:18432
    v_mfma_f32_16x16x32_bf16 v[56:59], v[24:27], v[84:87], v[56:59]
    ds_read_b128 v[44:47], v9 offset:36864
    v_mfma_f32_16x16x32_bf16 v[72:75], v[24:27], v[88:91], v[72:75]
    ds_read_b128 v[48:51], v9 offset:55296
    v_mfma_f32_16x16x32_bf16 v[60:63], v[28:31], v[84:87], v[60:63]
    v_mfma_f32_16x16x32_bf16 v[76:79], v[28:31], v[88:91], v[76:79]
    v_mfma_f32_16x16x32_bf16 v[64:67], v[32:35], v[84:87], v[64:67]
    v_mfma_f32_16x16x32_bf16 v[80:83], v[32:35], v[88:91], v[80:83]
    buffer_load_dwordx4 v[84:87], v3, s[16:19], s45 offen offset:0 sc1
    buffer_load_dwordx4 v[88:91], v3, s[16:19], s45 offen offset:1024 sc1
    s_add_u32 s45, s45, 4096
    s_waitcnt vmcnt(10) lgkmcnt(0)
    v_mfma_f32_16x16x32_bf16 v[52:55], v[36:39], v[92:95], v[52:55]
    ds_read_b128 v[20:23], v8 offset:128
    v_mfma_f32_16x16x32_bf16 v[68:71], v[36:39], v[96:99], v[68:71]
    ds_read_b128 v[24:27], v8 offset:18560
    v_mfma_f32_16x16x32_bf16 v[56:59], v[40:43], v[92:95], v[56:59]
    ds_read_b128 v[28:31], v8 offset:36992
    v_mfma_f32_16x16x32_bf16 v[72:75], v[40:43], v[96:99], v[72:75]
    ds_read_b128 v[32:35], v8 offset:55424
    v_mfma_f32_16x16x32_bf16 v[60:63], v[44:47], v[92:95], v[60:63]
    v_mfma_f32_16x16x32_bf16 v[76:79], v[44:47], v[96:99], v[76:79]
    v_mfma_f32_16x16x32_bf16 v[64:67], v[48:51], v[92:95], v[64:67]
    v_mfma_f32_16x16x32_bf16 v[80:83], v[48:51], v[96:99], v[80:83]
    buffer_load_dwordx4 v[92:95], v3, s[16:19], s45 offen offset:0 sc1
    buffer_load_dwordx4 v[96:99], v3, s[16:19], s45 offen offset:1024 sc1
    s_add_u32 s45, s45, 4096
    s_waitcnt vmcnt(10) lgkmcnt(0)
    v_mfma_f32_16x16x32_bf16 v[52:55], v[20:23], v[100:103], v[52:55]
    ds_read_b128 v[36:39], v9 offset:128
    v_mfma_f32_16x16x32_bf16 v[68:71], v[20:23], v[104:107], v[68:71]
    ds_read_b128 v[40:43], v9 offset:18560
    v_mfma_f32_16x16x32_bf16 v[56:59], v[24:27], v[100:103], v[56:59]
    ds_read_b128 v[44:47], v9 offset:36992
    v_mfma_f32_16x16x32_bf16 v[72:75], v[24:27], v[104:107], v[72:75]
    ds_read_b128 v[48:51], v9 offset:55424
    v_mfma_f32_16x16x32_bf16 v[60:63], v[28:31], v[100:103], v[60:63]
    v_mfma_f32_16x16x32_bf16 v[76:79], v[28:31], v[104:107], v[76:79]
    v_mfma_f32_16x16x32_bf16 v[64:67], v[32:35], v[100:103], v[64:67]
    v_mfma_f32_16x16x32_bf16 v[80:83], v[32:35], v[104:107], v[80:83]
    buffer_load_dwordx4 v[100:103], v3, s[16:19], s45 offen offset:0 sc1
    buffer_load_dwordx4 v[104:107], v3, s[16:19], s45 offen offset:1024 sc1
    s_add_u32 s45, s45, 4096
    s_waitcnt vmcnt(10) lgkmcnt(0)
    v_mfma_f32_16x16x32_bf16 v[52:55], v[36:39], v[108:111], v[52:55]
    ds_read_b128 v[20:23], v8 offset:256
    v_mfma_f32_16x16x32_bf16 v[68:71], v[36:39], v[112:115], v[68:71]
    ds_read_b128 v[24:27], v8 offset:18688
    v_mfma_f32_16x16x32_bf16 v[56:59], v[40:43], v[108:111], v[56:59]
    ds_read_b128 v[28:31], v8 offset:37120
    v_mfma_f32_16x16x32_bf16 v[72:75], v[40:43], v[112:115], v[72:75]
    ds_read_b128 v[32:35], v8 offset:55552
    v_mfma_f32_16x16x32_bf16 v[60:63], v[44:47], v[108:111], v[60:63]
    v_mfma_f32_16x16x32_bf16 v[76:79], v[44:47], v[112:115], v[76:79]
    v_mfma_f32_16x16x32_bf16 v[64:67], v[48:51], v[108:111], v[64:67]
    v_mfma_f32_16x16x32_bf16 v[80:83], v[48:51], v[112:115], v[80:83]
    buffer_load_dwordx4 v[108:111], v3, s[16:19], s45 offen offset:0 sc1
    buffer_load_dwordx4 v[112:115], v3, s[16:19], s45 offen offset:1024 sc1
    s_add_u32 s45, s45, 4096
    s_waitcnt vmcnt(10) lgkmcnt(0)
    v_mfma_f32_16x16x32_bf16 v[52:55], v[20:23], v[116:119], v[52:55]
    ds_read_b128 v[36:39], v9 offset:256
    v_mfma_f32_16x16x32_bf16 v[68:71], v[20:23], v[120:123], v[68:71]
    ds_read_b128 v[40:43], v9 offset:18688
    v_mfma_f32_16x16x32_bf16 v[56:59], v[24:27], v[116:119], v[56:59]
    ds_read_b128 v[44:47], v9 offset:37120
    v_mfma_f32_16x16x32_bf16 v[72:75], v[24:27], v[120:123], v[72:75]
    ds_read_b128 v[48:51], v9 offset:55552
    v_mfma_f32_16x16x32_bf16 v[60:63], v[28:31], v[116:119], v[60:63]
    v_mfma_f32_16x16x32_bf16 v[76:79], v[28:31], v[120:123], v[76:79]
    v_mfma_f32_16x16x32_bf16 v[64:67], v[32:35], v[116:119], v[64:67]
    v_mfma_f32_16x16x32_bf16 v[80:83], v[32:35], v[120:123], v[80:83]
    buffer_load_dwordx4 v[116:119], v3, s[16:19], s45 offen offset:0 sc1
    buffer_load_dwordx4 v[120:123], v3, s[16:19], s45 offen offset:1024 sc1
    s_add_u32 s45, s45, 4096
    s_waitcnt vmcnt(10) lgkmcnt(0)
    v_add_u32 v8, 384, v8
    v_add_u32 v9, 384, v9
    v_mfma_f32_16x16x32_bf16 v[52:55], v[36:39], v[124:127], v[52:55]
    ds_read_b128 v[20:23], v8 offset:0
    v_mfma_f32_16x16x32_bf16 v[68:71], v[36:39], v[128:131], v[68:71]
    ds_read_b128 v[24:27], v8 offset:18432
    v_mfma_f32_16x16x32_bf16 v[56:59], v[40:43], v[124:127], v[56:59]
    ds_read_b128 v[28:31], v8 offset:36864
    v_mfma_f32_16x16x32_bf16 v[72:75], v[40:43], v[128:131], v[72:75]
    ds_read_b128 v[32:35], v8 offset:55296
    v_mfma_f32_16x16x32_bf16 v[60:63], v[44:47], v[124:127], v[60:63]
    v_mfma_f32_16x16x32_bf16 v[76:79], v[44:47], v[128:131], v[76:79]
    v_mfma_f32_16x16x32_bf16 v[64:67], v[48:51], v[124:127], v[64:67]
    v_mfma_f32_16x16x32_bf16 v[80:83], v[48:51], v[128:131], v[80:83]
    buffer_load_dwordx4 v[124:127], v3, s[16:19], s45 offen offset:0 sc1
    buffer_load_dwordx4 v[128:131], v3, s[16:19], s45 offen offset:1024 sc1
    s_add_u32 s45, s45, 4096
    s_sub_u32 s47, s47, 1
    s_cmp_lg_u32 s47, 0
    s_cbranch_scc1 Lk_6
    s_waitcnt vmcnt(10) lgkmcnt(0)
    v_mfma_f32_16x16x32_bf16 v[52:55], v[20:23], v[84:87], v[52:55]
    ds_read_b128 v[36:39], v9 offset:0
    v_mfma_f32_16x16x32_bf16 v[68:71], v[20:23], v[88:91], v[68:71]
    ds_read_b128 v[40:43], v9 offset:18432
    v_mfma_f32_16x16x32_bf16 v[56:59], v[24:27], v[84:87], v[56:59]
    ds_read_b128 v[44:47], v9 offset:36864
    v_mfma_f32_16x16x32_bf16 v[72:75], v[24:27], v[88:91], v[72:75]
    ds_read_b128 v[48:51], v9 offset:55296
    v_mfma_f32_16x16x32_bf16 v[60:63], v[28:31], v[84:87], v[60:63]
    v_mfma_f32_16x16x32_bf16 v[76:79], v[28:31], v[88:91], v[76:79]
    v_mfma_f32_16x16x32_bf16 v[64:67], v[32:35], v[84:87], v[64:67]
    v_mfma_f32_16x16x32_bf16 v[80:83], v[32:35], v[88:91], v[80:83]
    s_waitcnt vmcnt(8) lgkmcnt(0)
    v_mfma_f32_16x16x32_bf16 v[52:55], v[36:39], v[92:95], v[52:55]
    ds_read_b128 v[20:23], v8 offset:128
    v_mfma_f32_16x16x32_bf16 v[68:71], v[36:39], v[96:99], v[68:71]
    ds_read_b128 v[24:27], v8 offset:18560
    v_mfma_f32_16x16x32_bf16 v[56:59], v[40:43], v[92:95], v[56:59]
    ds_read_b128 v[28:31], v8 offset:36992
    v_mfma_f32_16x16x32_bf16 v[72:75], v[40:43], v[96:99], v[72:75]
    ds_read_b128 v[32:35], v8 offset:55424
    v_mfma_f32_16x16x32_bf16 v[60:63], v[44:47], v[92:95], v[60:63]
    v_mfma_f32_16x16x32_bf16 v[76:79], v[44:47], v[96:99], v[76:79]
    v_mfma_f32_16x16x32_bf16 v[64:67], v[48:51], v[92:95], v[64:67]
    v_mfma_f32_16x16x32_bf16 v[80:83], v[48:51], v[96:99], v[80:83]
    s_waitcnt vmcnt(6) lgkmcnt(0)
    v_mfma_f32_16x16x32_bf16 v[52:55], v[20:23], v[100:103], v[52:55]
    ds_read_b128 v[36:39], v9 offset:128
    v_mfma_f32_16x16x32_bf16 v[68:71], v[20:23], v[104:107], v[68:71]
    ds_read_b128 v[40:43], v9 offset:18560
    v_mfma_f32_16x16x32_bf16 v[56:59], v[24:27], v[100:103], v[56:59]
    ds_read_b128 v[44:47], v9 offset:36992
    v_mfma_f32_16x16x32_bf16 v[72:75], v[24:27], v[104:107], v[72:75]
    ds_read_b128 v[48:51], v9 offset:55424
    v_mfma_f32_16x16x32_bf16 v[60:63], v[28:31], v[100:103], v[60:63]
    v_mfma_f32_16x16x32_bf16 v[76:79], v[28:31], v[104:107], v[76:79]
    v_mfma_f32_16x16x32_bf16 v[64:67], v[32:35], v[100:103], v[64:67]
    v_mfma_f32_16x16x32_bf16 v[80:83], v[32:35], v[104:107], v[80:83]
    s_waitcnt vmcnt(4) lgkmcnt(0)
    v_mfma_f32_16x16x32_bf16 v[52:55], v[36:39], v[108:111], v[52:55]
    ds_read_b128 v[20:23], v8 offset:256
    v_mfma_f32_16x16x32_bf16 v[68:71], v[36:39], v[112:115], v[68:71]
    ds_read_b128 v[24:27], v8 offset:18688
    v_mfma_f32_16x16x32_bf16 v[56:59], v[40:43], v[108:111], v[56:59]
    ds_read_b128 v[28:31], v8 offset:37120
    v_mfma_f32_16x16x32_bf16 v[72:75], v[40:43], v[112:115], v[72:75]
    ds_read_b128 v[32:35], v8 offset:55552
    v_mfma_f32_16x16x32_bf16 v[60:63], v[44:47], v[108:111], v[60:63]
    v_mfma_f32_16x16x32_bf16 v[76:79], v[44:47], v[112:115], v[76:79]
    v_mfma_f32_16x16x32_bf16 v[64:67], v[48:51], v[108:111], v[64:67]
    v_mfma_f32_16x16x32_bf16 v[80:83], v[48:51], v[112:115], v[80:83]
    s_waitcnt vmcnt(2) lgkmcnt(0)
    v_mfma_f32_16x16x32_bf16 v[52:55], v[20:23], v[116:119], v[52:55]
    ds_read_b128 v[36:39], v9 offset:256
    v_mfma_f32_16x16x32_bf16 v[68:71], v[20:23], v[120:123], v[68:71]
    ds_read_b128 v[40:43], v9 offset:18688
    v_mfma_f32_16x16x32_bf16 v[56:59], v[24:27], v[116:119], v[56:59]
    ds_read_b128 v[44:47], v9 offset:37120
    v_mfma_f32_16x16x32_bf16 v[72:75], v[24:27], v[120:123], v[72:75]
    ds_read_b128 v[48:51], v9 offset:55552
    v_mfma_f32_16x16x32_bf16 v[60:63], v[28:31], v[116:119], v[60:63]
    v_mfma_f32_16x16x32_bf16 v[76:79], v[28:31], v[120:123], v[76:79]
    v_mfma_f32_16x16x32_bf16 v[64:67], v[32:35], v[116:119], v[64:67]
    v_mfma_f32_16x16x32_bf16 v[80:83], v[32:35], v[120:123], v[80:83]
    s_waitcnt vmcnt(0) lgkmcnt(0)
    v_mfma_f32_16x16x32_bf16 v[52:55], v[36:39], v[124:127], v[52:55]
    v_mfma_f32_16x16x32_bf16 v[68:71], v[36:39], v[128:131], v[68:71]
    v_mfma_f32_16x16x32_bf16 v[56:59], v[40:43], v[124:127], v[56:59]
    v_mfma_f32_16x16x32_bf16 v[72:75], v[40:43], v[128:131], v[72:75]
    v_mfma_f32_16x16x32_bf16 v[60:63], v[44:47], v[124:127], v[60:63]
    v_mfma_f32_16x16x32_bf16 v[76:79], v[44:47], v[128:131], v[76:79]
    v_mfma_f32_16x16x32_bf16 v[64:67], v[48:51], v[124:127], v[64:67]
    v_mfma_f32_16x16x32_bf16 v[80:83], v[48:51], v[128:131], v[80:83]
    s_mov_b32 s40, 0x3fb8aa3b
    s_mov_b32 s41, 0x3fb8aa3b
    s_mov_b32 s42, 0x358637bd
    s_mov_b32 s43, 0x358637bd
    v_pk_mul_f32 v[12:13], v[52:53], s[40:41]
    v_pk_mul_f32 v[14:15], v[54:55], s[40:41]
    v_exp_f32 v12, v12 clamp
    v_exp_f32 v13, v13 clamp
    v_exp_f32 v14, v14 clamp
    v_exp_f32 v15, v15 clamp
    v_max_f32 v16, 0, v52
    v_max_f32 v17, 0, v53
    v_max_f32 v18, 0, v54
    v_max_f32 v19, 0, v55
    v_pk_add_f32 v[12:13], v[12:13], s[42:43]
    v_pk_add_f32 v[14:15], v[14:15], s[42:43]
    v_pk_add_f32 v[52:53], v[12:13], v[16:17]
    v_pk_add_f32 v[54:55], v[14:15], v[18:19]
    v_pk_mul_f32 v[12:13], v[56:57], s[40:41]
    v_pk_mul_f32 v[14:15], v[58:59], s[40:41]
    v_exp_f32 v12, v12 clamp
    v_exp_f32 v13, v13 clamp
    v_exp_f32 v14, v14 clamp
    v_exp_f32 v15, v15 clamp
    v_max_f32 v16, 0, v56
    v_max_f32 v17, 0, v57
    v_max_f32 v18, 0, v58
    v_max_f32 v19, 0, v59
    v_pk_add_f32 v[12:13], v[12:13], s[42:43]
    v_pk_add_f32 v[14:15], v[14:15], s[42:43]
    v_pk_add_f32 v[56:57], v[12:13], v[16:17]
    v_pk_add_f32 v[58:59], v[14:15], v[18:19]
    v_pk_mul_f32 v[12:13], v[60:61], s[40:41]
    v_pk_mul_f32 v[14:15], v[62:63], s[40:41]
    v_exp_f32 v12, v12 clamp
    v_exp_f32 v13, v13 clamp
    v_exp_f32 v14, v14 clamp
    v_exp_f32 v15, v15 clamp
    v_max_f32 v16, 0, v60
    v_max_f32 v17, 0, v61
    v_max_f32 v18, 0, v62
    v_max_f32 v19, 0, v63
    v_pk_add_f32 v[12:13], v[12:13], s[42:43]
    v_pk_add_f32 v[14:15], v[14:15], s[42:43]
    v_pk_add_f32 v[60:61], v[12:13], v[16:17]
    v_pk_add_f32 v[62:63], v[14:15], v[18:19]
    v_pk_mul_f32 v[12:13], v[64:65], s[40:41]
    v_pk_mul_f32 v[14:15], v[66:67], s[40:41]
    v_exp_f32 v12, v12 clamp
    v_exp_f32 v13, v13 clamp
    v_exp_f32 v14, v14 clamp
    v_exp_f32 v15, v15 clamp
    v_max_f32 v16, 0, v64
    v_max_f32 v17, 0, v65
    v_max_f32 v18, 0, v66
    v_max_f32 v19, 0, v67
    v_pk_add_f32 v[12:13], v[12:13], s[42:43]
    v_pk_add_f32 v[14:15], v[14:15], s[42:43]
    v_pk_add_f32 v[64:65], v[12:13], v[16:17]
    v_pk_add_f32 v[66:67], v[14:15], v[18:19]
    v_cvt_pk_bf16_f32 v20, v52, v53
    v_cvt_pk_bf16_f32 v21, v54, v55
    v_cvt_pk_bf16_f32 v22, v56, v57
    v_cvt_pk_bf16_f32 v23, v58, v59
    v_cvt_pk_bf16_f32 v24, v60, v61
    v_cvt_pk_bf16_f32 v25, v62, v63
    v_cvt_pk_bf16_f32 v26, v64, v65
    v_cvt_pk_bf16_f32 v27, v66, v67
    v_cvt_pk_bf16_f32 v28, v68, v69
    v_cvt_pk_bf16_f32 v29, v70, v71
    v_cvt_pk_bf16_f32 v30, v72, v73
    v_cvt_pk_bf16_f32 v31, v74, v75
    v_cvt_pk_bf16_f32 v32, v76, v77
    v_cvt_pk_bf16_f32 v33, v78, v79
    v_cvt_pk_bf16_f32 v34, v80, v81
    v_cvt_pk_bf16_f32 v35, v82, v83
    v_mfma_f32_16x16x32_bf16 v[132:135], v[28:31], v[20:23], 0
    s_nop 0
    v_mfma_f32_16x16x32_bf16 v[132:135], v[32:35], v[24:27], v[132:135]
    s_lshl_b32 s31, s44, 2
    s_add_u32 s31, s31, 147456
    v_mov_b32 v12, s31
    s_mov_b32 s72, 0x100000
Llf_7:
    ds_read_b32 v13, v12
    s_waitcnt lgkmcnt(0)
    v_cmp_ne_u32 vcc, 0, v13
    s_cbranch_vccnz Llfd_8
    s_sub_u32 s72, s72, 1
    s_cbranch_scc0 Llf_7
Llfd_8:
    s_lshl_b32 s31, s44, 11
    s_add_u32 s31, s31, 147520
    v_add_u32 v12, s31, v3
    ds_read_b128 v[36:39], v12
    ds_read_b128 v[40:43], v12 offset:1024
    s_waitcnt lgkmcnt(0)
    v_mfma_f32_16x16x32_bf16 v[136:139], v[36:39], v[20:23], 0
    v_mfma_f32_16x16x32_bf16 v[140:143], v[36:39], v[28:31], 0
    v_mfma_f32_16x16x32_bf16 v[144:147], v[36:39], v[36:39], 0
    v_mfma_f32_16x16x32_bf16 v[136:139], v[40:43], v[24:27], v[136:139]
    v_mfma_f32_16x16x32_bf16 v[140:143], v[40:43], v[32:35], v[140:143]
    v_mfma_f32_16x16x32_bf16 v[144:147], v[40:43], v[40:43], v[144:147]
    s_lshl_b32 s31, s48, 2
    s_add_u32 s31, s31, s44
    s_mul_i32 s31, s31, 1536
    s_add_u32 s31, s31, 0x30000
    s_and_b32 s56, s44, 1
    s_sub_u32 s56, 0, s56
    s_mov_b32 s57, s56
    s_and_b64 s[58:59], s[56:57], s[66:67]
    v_and_b32 v12, 15, v1
    v_lshrrev_b32 v13, 4, v1
    v_lshlrev_b32 v14, 8, v13
    v_lshl_add_u32 v14, v12, 2, v14
    buffer_atomic_add_f32 v132, v14, s[16:19], s31 offen offset:0
    buffer_atomic_add_f32 v133, v14, s[16:19], s31 offen offset:64
    buffer_atomic_add_f32 v134, v14, s[16:19], s31 offen offset:128
    buffer_atomic_add_f32 v135, v14, s[16:19], s31 offen offset:192
    v_lshlrev_b32 v14, 6, v13
    v_add_u32 v14, 960, v14
    v_lshl_add_u32 v14, v12, 2, v14
    v_cndmask_b32 v15, v136, v138, s[58:59]
    s_or_b64 s[60:61], s[66:67], s[70:71]
    s_mov_b64 exec, s[60:61]
    buffer_atomic_add_f32 v15, v14, s[16:19], s31 offen
    s_mov_b64 exec, s[66:67]
    v_cndmask_b32 v17, v137, v139, s[56:57]
    buffer_atomic_add_f32 v17, v14, s[16:19], s31 offen offset:64
    s_mov_b64 exec, s[64:65]
    v_lshlrev_b32 v16, 2, v12
    v_cndmask_b32 v18, v140, v142, s[56:57]
    v_cndmask_b32 v19, v141, v143, s[56:57]
    buffer_atomic_add_f32 v18, v16, s[16:19], s31 offen offset:1280
    buffer_atomic_add_f32 v19, v16, s[16:19], s31 offen offset:1408
    s_mov_b64 exec, -1
    s_and_b32 s52, s44, 1
    s_lshl_b32 s52, s52, 1
    s_lshl_b32 s53, 0x00030003, s52
    s_mov_b32 s62, s53
    s_mov_b32 s63, s53
    v_subrev_u32 v16, s52, v12
    v_lshlrev_b32 v16, 7, v16
    v_lshl_add_u32 v16, v13, 2, v16
    v_add_u32 v16, 1340, v16
    v_cndmask_b32 v148, v144, v146, s[58:59]
    v_cndmask_b32 v149, v145, v147, s[56:57]
    s_and_b64 exec, s[60:61], s[62:63]
    buffer_atomic_add_f32 v148, v16, s[16:19], s31 offen
    s_and_b64 exec, s[66:67], s[62:63]
    buffer_atomic_add_f32 v149, v16, s[16:19], s31 offen offset:4
    s_mov_b64 exec, -1
    s_branch L_p1_end
L_p1_q:
    s_sub_u32 s44, s3, 4
    s_lshl_b32 s31, s48, 2
    s_add_u32 s31, s31, s44
    s_mul_i32 s45, s31, 73728
    s_add_u32 s45, s45, 0x1720800
    v_lshlrev_b32 v3, 4, v1
    v_and_b32 v12, 15, v1
    v_lshrrev_b32 v13, 4, v1
    v_and_b32 v14, 7, v12
    v_mul_u32_u24 v15, 1152, v12
    v_xor_b32 v16, v13, v14
    v_lshl_add_u32 v8, v16, 4, v15
    v_or_b32 v16, 4, v13
    v_xor_b32 v16, v16, v14
    v_lshl_add_u32 v9, v16, 4, v15
    s_setprio 1
    s_lshl_b32 s31, s3, 6
    v_add_u32 v12, s31, v1
    v_mul_u32_u24 v13, 911, v12
    v_lshrrev_b32 v13, 16, v13
    v_mul_u32_u24 v14, 72, v13
    v_sub_u32 v14, v12, v14
    v_xor_b32 v14, v14, v13
    v_mul_u32_u24 v13, 1152, v13
    v_lshl_add_u32 v4, v14, 4, v13
    s_mul_i32 s33, s49, 73728
    s_add_u32 s33, s33, 0x1960000
    s_lshl_b32 s31, s3, 10
    s_mov_b32 m0, s31
    s_add_u32 s31, s31, 9216
    buffer_load_dwordx4 v4, s[16:19], s33 offen sc1 lds
    s_add_u32 s33, s33, 9216
    s_mov_b32 m0, s31
    s_add_u32 s31, s31, 9216
    buffer_load_dwordx4 v4, s[16:19], s33 offen sc1 lds
    s_add_u32 s33, s33, 9216
    s_mov_b32 m0, s31
    s_add_u32 s31, s31, 9216
    buffer_load_dwordx4 v4, s[16:19], s33 offen sc1 lds
    s_add_u32 s33, s33, 9216
    s_mov_b32 m0, s31
    s_add_u32 s31, s31, 9216
    buffer_load_dwordx4 v4, s[16:19], s33 offen sc1 lds
    s_add_u32 s33, s33, 9216
    s_mov_b32 m0, s31
    s_add_u32 s31, s31, 9216
    buffer_load_dwordx4 v4, s[16:19], s33 offen sc1 lds
    s_add_u32 s33, s33, 9216
    s_mov_b32 m0, s31
    s_add_u32 s31, s31, 9216
    buffer_load_dwordx4 v4, s[16:19], s33 offen sc1 lds
    s_add_u32 s33, s33, 9216
    s_mov_b32 m0, s31
    s_add_u32 s31, s31, 9216
    buffer_load_dwordx4 v4, s[16:19], s33 offen sc1 lds
    s_add_u32 s33, s33, 9216
    s_mov_b32 m0, s31
    s_add_u32 s31, s31, 9216
    buffer_load_dwordx4 v4, s[16:19], s33 offen sc1 lds
    s_add_u32 s33, s33, 9216
    s_cmp_eq_u32 s3, 0
    s_cbranch_scc0 Lp1w_9
    s_mul_i32 s31, s48, 18
    s_add_u32 s33, s48, 230
    v_add_u32 v12, s31, v1
    v_add_u32 v13, s33, v1
    v_cmp_lt_u32 vcc, 17, v1
    s_nop 1
    v_cndmask_b32 v12, v12, v13, vcc
    v_lshlrev_b32 v12, 7, v12
    v_add_u32 v12, 0x8000, v12
    s_mov_b32 exec_lo, 0x7ffff
    s_mov_b32 exec_hi, 0x0
    s_mov_b32 s72, 0x40000
Lpoll_10:
    buffer_load_dword v13, v12, s[16:19], 0 offen sc1
    s_waitcnt vmcnt(0)
    v_cmp_ne_u32 vcc, s28, v13
    s_cbranch_vccz Lpolld_11
    s_sub_u32 s72, s72, 1
    s_cbranch_scc1 Lpolld_11
    s_sleep 2
    s_branch Lpoll_10
Lpolld_11:
    s_mov_b64 exec, -1
Lp1w_9:
    s_barrier
    buffer_load_dwordx4 v[84:87], v3, s[16:19], s45 offen offset:0 sc1
    buffer_load_dwordx4 v[88:91], v3, s[16:19], s45 offen offset:1024 sc1
    s_add_u32 s45, s45, 4096
    buffer_load_dwordx4 v[92:95], v3, s[16:19], s45 offen offset:0 sc1
    buffer_load_dwordx4 v[96:99], v3, s[16:19], s45 offen offset:1024 sc1
    s_add_u32 s45, s45, 4096
    buffer_load_dwordx4 v[100:103], v3, s[16:19], s45 offen offset:0 sc1
    buffer_load_dwordx4 v[104:107], v3, s[16:19], s45 offen offset:1024 sc1
    s_add_u32 s45, s45, 4096
    buffer_load_dwordx4 v[108:111], v3, s[16:19], s45 offen offset:0 sc1
    buffer_load_dwordx4 v[112:115], v3, s[16:19], s45 offen offset:1024 sc1
    s_add_u32 s45, s45, 4096
    buffer_load_dwordx4 v[116:119], v3, s[16:19], s45 offen offset:0 sc1
    buffer_load_dwordx4 v[120:123], v3, s[16:19], s45 offen offset:1024 sc1
    s_add_u32 s45, s45, 4096
    buffer_load_dwordx4 v[124:127], v3, s[16:19], s45 offen offset:0 sc1
    buffer_load_dwordx4 v[128:131], v3, s[16:19], s45 offen offset:1024 sc1
    s_add_u32 s45, s45, 4096
    v_mov_b32 v52, 0
    v_mov_b32 v53, 0
    v_mov_b32 v54, 0
    v_mov_b32 v55, 0
    v_mov_b32 v56, 0
    v_mov_b32 v57, 0
    v_mov_b32 v58, 0
    v_mov_b32 v59, 0
    v_mov_b32 v60, 0
    v_mov_b32 v61, 0
    v_mov_b32 v62, 0
    v_mov_b32 v63, 0
    v_mov_b32 v64, 0
    v_mov_b32 v65, 0
    v_mov_b32 v66, 0
    v_mov_b32 v67, 0
    s_mov_b32 s52, 0x10001000
    s_mov_b32 s53, 0x10001000
    v_cndmask_b32 v68, 0, 1.0, s[52:53]
    v_mov_b32 v69, v68
    v_mov_b32 v70, v68
    v_mov_b32 v71, v68
    v_mov_b32 v72, v68
    v_mov_b32 v73, v68
    v_mov_b32 v74, v68
    v_mov_b32 v75, v68
    v_mov_b32 v76, v68
    v_mov_b32 v77, v68
    v_mov_b32 v78, v68
    v_mov_b32 v79, v68
    v_mov_b32 v80, v68
    v_mov_b32 v81, v68
    v_mov_b32 v82, v68
    v_mov_b32 v83, v68
    s_waitcnt vmcnt(12)
    s_barrier
    ds_read_b128 v[20:23], v8 offset:0
    ds_read_b128 v[24:27], v8 offset:18432
    ds_read_b128 v[28:31], v8 offset:36864
    ds_read_b128 v[32:35], v8 offset:55296
    s_mov_b32 s47, 2
Lk_12:
    s_waitcnt vmcnt(10) lgkmcnt(0)
    v_mfma_f32_16x16x32_bf16 v[52:55], v[84:87], v[20:23], v[52:55]
    ds_read_b128 v[36:39], v9 offset:0
    v_mfma_f32_16x16x32_bf16 v[68:71], v[20:23], v[88:91], v[68:71]
    ds_read_b128 v[40:43], v9 offset:18432
    v_mfma_f32_16x16x32_bf16 v[56:59], v[84:87], v[24:27], v[56:59]
    ds_read_b128 v[44:47], v9 offset:36864
    v_mfma_f32_16x16x32_bf16 v[72:75], v[24:27], v[88:91], v[72:75]
    ds_read_b128 v[48:51], v9 offset:55296
    v_mfma_f32_16x16x32_bf16 v[60:63], v[84:87], v[28:31], v[60:63]
    v_mfma_f32_16x16x32_bf16 v[76:79], v[28:31], v[88:91], v[76:79]
    v_mfma_f32_16x16x32_bf16 v[64:67], v[84:87], v[32:35], v[64:67]
    v_mfma_f32_16x16x32_bf16 v[80:83], v[32:35], v[88:91], v[80:83]
    buffer_load_dwordx4 v[84:87], v3, s[16:19], s45 offen offset:0 sc1
    buffer_load_dwordx4 v[88:91], v3, s[16:19], s45 offen offset:1024 sc1
    s_add_u32 s45, s45, 4096
    s_waitcnt vmcnt(10) lgkmcnt(0)
    v_mfma_f32_16x16x32_bf16 v[52:55], v[92:95], v[36:39], v[52:55]
    ds_read_b128 v[20:23], v8 offset:128
    v_mfma_f32_16x16x32_bf16 v[68:71], v[36:39], v[96:99], v[68:71]
    ds_read_b128 v[24:27], v8 offset:18560
    v_mfma_f32_16x16x32_bf16 v[56:59], v[92:95], v[40:43], v[56:59]
    ds_read_b128 v[28:31], v8 offset:36992
    v_mfma_f32_16x16x32_bf16 v[72:75], v[40:43], v[96:99], v[72:75]
    ds_read_b128 v[32:35], v8 offset:55424
    v_mfma_f32_16x16x32_bf16 v[60:63], v[92:95], v[44:47], v[60:63]
    v_mfma_f32_16x16x32_bf16 v[76:79], v[44:47], v[96:99], v[76:79]
    v_mfma_f32_16x16x32_bf16 v[64:67], v[92:95], v[48:51], v[64:67]
    v_mfma_f32_16x16x32_bf16 v[80:83], v[48:51], v[96:99], v[80:83]
    buffer_load_dwordx4 v[92:95], v3, s[16:19], s45 offen offset:0 sc1
    buffer_load_dwordx4 v[96:99], v3, s[16:19], s45 offen offset:1024 sc1
    s_add_u32 s45, s45, 4096
    s_waitcnt vmcnt(10) lgkmcnt(0)
    v_mfma_f32_16x16x32_bf16 v[52:55], v[100:103], v[20:23], v[52:55]
    ds_read_b128 v[36:39], v9 offset:128
    v_mfma_f32_16x16x32_bf16 v[68:71], v[20:23], v[104:107], v[68:71]
    ds_read_b128 v[40:43], v9 offset:18560
    v_mfma_f32_16x16x32_bf16 v[56:59], v[100:103], v[24:27], v[56:59]
    ds_read_b128 v[44:47], v9 offset:36992
    v_mfma_f32_16x16x32_bf16 v[72:75], v[24:27], v[104:107], v[72:75]
    ds_read_b128 v[48:51], v9 offset:55424
    v_mfma_f32_16x16x32_bf16 v[60:63], v[100:103], v[28:31], v[60:63]
    v_mfma_f32_16x16x32_bf16 v[76:79], v[28:31], v[104:107], v[76:79]
    v_mfma_f32_16x16x32_bf16 v[64:67], v[100:103], v[32:35], v[64:67]
    v_mfma_f32_16x16x32_bf16 v[80:83], v[32:35], v[104:107], v[80:83]
    buffer_load_dwordx4 v[100:103], v3, s[16:19], s45 offen offset:0 sc1
    buffer_load_dwordx4 v[104:107], v3, s[16:19], s45 offen offset:1024 sc1
    s_add_u32 s45, s45, 4096
    s_waitcnt vmcnt(10) lgkmcnt(0)
    v_mfma_f32_16x16x32_bf16 v[52:55], v[108:111], v[36:39], v[52:55]
    ds_read_b128 v[20:23], v8 offset:256
    v_mfma_f32_16x16x32_bf16 v[68:71], v[36:39], v[112:115], v[68:71]
    ds_read_b128 v[24:27], v8 offset:18688
    v_mfma_f32_16x16x32_bf16 v[56:59], v[108:111], v[40:43], v[56:59]
    ds_read_b128 v[28:31], v8 offset:37120
    v_mfma_f32_16x16x32_bf16 v[72:75], v[40:43], v[112:115], v[72:75]
    ds_read_b128 v[32:35], v8 offset:55552
    v_mfma_f32_16x16x32_bf16 v[60:63], v[108:111], v[44:47], v[60:63]
    v_mfma_f32_16x16x32_bf16 v[76:79], v[44:47], v[112:115], v[76:79]
    v_mfma_f32_16x16x32_bf16 v[64:67], v[108:111], v[48:51], v[64:67]
    v_mfma_f32_16x16x32_bf16 v[80:83], v[48:51], v[112:115], v[80:83]
    buffer_load_dwordx4 v[108:111], v3, s[16:19], s45 offen offset:0 sc1
    buffer_load_dwordx4 v[112:115], v3, s[16:19], s45 offen offset:1024 sc1
    s_add_u32 s45, s45, 4096
    s_waitcnt vmcnt(10) lgkmcnt(0)
    v_mfma_f32_16x16x32_bf16 v[52:55], v[116:119], v[20:23], v[52:55]
    ds_read_b128 v[36:39], v9 offset:256
    v_mfma_f32_16x16x32_bf16 v[68:71], v[20:23], v[120:123], v[68:71]
    ds_read_b128 v[40:43], v9 offset:18688
    v_mfma_f32_16x16x32_bf16 v[56:59], v[116:119], v[24:27], v[56:59]
    ds_read_b128 v[44:47], v9 offset:37120
    v_mfma_f32_16x16x32_bf16 v[72:75], v[24:27], v[120:123], v[72:75]
    ds_read_b128 v[48:51], v9 offset:55552
    v_mfma_f32_16x16x32_bf16 v[60:63], v[116:119], v[28:31], v[60:63]
    v_mfma_f32_16x16x32_bf16 v[76:79], v[28:31], v[120:123], v[76:79]
    v_mfma_f32_16x16x32_bf16 v[64:67], v[116:119], v[32:35], v[64:67]
    v_mfma_f32_16x16x32_bf16 v[80:83], v[32:35], v[120:123], v[80:83]
    buffer_load_dwordx4 v[116:119], v3, s[16:19], s45 offen offset:0 sc1
    buffer_load_dwordx4 v[120:123], v3, s[16:19], s45 offen offset:1024 sc1
    s_add_u32 s45, s45, 4096
    s_waitcnt vmcnt(10) lgkmcnt(0)
    v_add_u32 v8, 384, v8
    v_add_u32 v9, 384, v9
    v_mfma_f32_16x16x32_bf16 v[52:55], v[124:127], v[36:39], v[52:55]
    ds_read_b128 v[20:23], v8 offset:0
    v_mfma_f32_16x16x32_bf16 v[68:71], v[36:39], v[128:131], v[68:71]
    ds_read_b128 v[24:27], v8 offset:18432
    v_mfma_f32_16x16x32_bf16 v[56:59], v[124:127], v[40:43], v[56:59]
    ds_read_b128 v[28:31], v8 offset:36864
    v_mfma_f32_16x16x32_bf16 v[72:75], v[40:43], v[128:131], v[72:75]
    ds_read_b128 v[32:35], v8 offset:55296
    v_mfma_f32_16x16x32_bf16 v[60:63], v[124:127], v[44:47], v[60:63]
    v_mfma_f32_16x16x32_bf16 v[76:79], v[44:47], v[128:131], v[76:79]
    v_mfma_f32_16x16x32_bf16 v[64:67], v[124:127], v[48:51], v[64:67]
    v_mfma_f32_16x16x32_bf16 v[80:83], v[48:51], v[128:131], v[80:83]
    buffer_load_dwordx4 v[124:127], v3, s[16:19], s45 offen offset:0 sc1
    buffer_load_dwordx4 v[128:131], v3, s[16:19], s45 offen offset:1024 sc1
    s_add_u32 s45, s45, 4096
    s_sub_u32 s47, s47, 1
    s_cmp_lg_u32 s47, 0
    s_cbranch_scc1 Lk_12
    s_waitcnt vmcnt(10) lgkmcnt(0)
    v_mfma_f32_16x16x32_bf16 v[52:55], v[84:87], v[20:23], v[52:55]
    ds_read_b128 v[36:39], v9 offset:0
    v_mfma_f32_16x16x32_bf16 v[68:71], v[20:23], v[88:91], v[68:71]
    ds_read_b128 v[40:43], v9 offset:18432
    v_mfma_f32_16x16x32_bf16 v[56:59], v[84:87], v[24:27], v[56:59]
    ds_read_b128 v[44:47], v9 offset:36864
    v_mfma_f32_16x16x32_bf16 v[72:75], v[24:27], v[88:91], v[72:75]
    ds_read_b128 v[48:51], v9 offset:55296
    v_mfma_f32_16x16x32_bf16 v[60:63], v[84:87], v[28:31], v[60:63]
    v_mfma_f32_16x16x32_bf16 v[76:79], v[28:31], v[88:91], v[76:79]
    v_mfma_f32_16x16x32_bf16 v[64:67], v[84:87], v[32:35], v[64:67]
    v_mfma_f32_16x16x32_bf16 v[80:83], v[32:35], v[88:91], v[80:83]
    s_waitcnt vmcnt(8) lgkmcnt(0)
    v_mfma_f32_16x16x32_bf16 v[52:55], v[92:95], v[36:39], v[52:55]
    ds_read_b128 v[20:23], v8 offset:128
    v_mfma_f32_16x16x32_bf16 v[68:71], v[36:39], v[96:99], v[68:71]
    ds_read_b128 v[24:27], v8 offset:18560
    v_mfma_f32_16x16x32_bf16 v[56:59], v[92:95], v[40:43], v[56:59]
    ds_read_b128 v[28:31], v8 offset:36992
    v_mfma_f32_16x16x32_bf16 v[72:75], v[40:43], v[96:99], v[72:75]
    ds_read_b128 v[32:35], v8 offset:55424
    v_mfma_f32_16x16x32_bf16 v[60:63], v[92:95], v[44:47], v[60:63]
    v_mfma_f32_16x16x32_bf16 v[76:79], v[44:47], v[96:99], v[76:79]
    v_mfma_f32_16x16x32_bf16 v[64:67], v[92:95], v[48:51], v[64:67]
    v_mfma_f32_16x16x32_bf16 v[80:83], v[48:51], v[96:99], v[80:83]
    s_waitcnt vmcnt(6) lgkmcnt(0)
    v_mfma_f32_16x16x32_bf16 v[52:55], v[100:103], v[20:23], v[52:55]
    ds_read_b128 v[36:39], v9 offset:128
    v_mfma_f32_16x16x32_bf16 v[68:71], v[20:23], v[104:107], v[68:71]
    ds_read_b128 v[40:43], v9 offset:18560
    v_mfma_f32_16x16x32_bf16 v[56:59], v[100:103], v[24:27], v[56:59]
    ds_read_b128 v[44:47], v9 offset:36992
    v_mfma_f32_16x16x32_bf16 v[72:75], v[24:27], v[104:107], v[72:75]
    ds_read_b128 v[48:51], v9 offset:55424
    v_mfma_f32_16x16x32_bf16 v[60:63], v[100:103], v[28:31], v[60:63]
    v_mfma_f32_16x16x32_bf16 v[76:79], v[28:31], v[104:107], v[76:79]
    v_mfma_f32_16x16x32_bf16 v[64:67], v[100:103], v[32:35], v[64:67]
    v_mfma_f32_16x16x32_bf16 v[80:83], v[32:35], v[104:107], v[80:83]
    s_waitcnt vmcnt(4) lgkmcnt(0)
    v_mfma_f32_16x16x32_bf16 v[52:55], v[108:111], v[36:39], v[52:55]
    ds_read_b128 v[20:23], v8 offset:256
    v_mfma_f32_16x16x32_bf16 v[68:71], v[36:39], v[112:115], v[68:71]
    ds_read_b128 v[24:27], v8 offset:18688
    v_mfma_f32_16x16x32_bf16 v[56:59], v[108:111], v[40:43], v[56:59]
    ds_read_b128 v[28:31], v8 offset:37120
    v_mfma_f32_16x16x32_bf16 v[72:75], v[40:43], v[112:115], v[72:75]
    ds_read_b128 v[32:35], v8 offset:55552
    v_mfma_f32_16x16x32_bf16 v[60:63], v[108:111], v[44:47], v[60:63]
    v_mfma_f32_16x16x32_bf16 v[76:79], v[44:47], v[112:115], v[76:79]
    v_mfma_f32_16x16x32_bf16 v[64:67], v[108:111], v[48:51], v[64:67]
    v_mfma_f32_16x16x32_bf16 v[80:83], v[48:51], v[112:115], v[80:83]
    s_waitcnt vmcnt(2) lgkmcnt(0)
    v_mfma_f32_16x16x32_bf16 v[52:55], v[116:119], v[20:23], v[52:55]
    ds_read_b128 v[36:39], v9 offset:256
    v_mfma_f32_16x16x32_bf16 v[68:71], v[20:23], v[120:123], v[68:71]
    ds_read_b128 v[40:43], v9 offset:18688
    v_mfma_f32_16x16x32_bf16 v[56:59], v[116:119], v[24:27], v[56:59]
    ds_read_b128 v[44:47], v9 offset:37120
    v_mfma_f32_16x16x32_bf16 v[72:75], v[24:27], v[120:123], v[72:75]
    ds_read_b128 v[48:51], v9 offset:55552
    v_mfma_f32_16x16x32_bf16 v[60:63], v[116:119], v[28:31], v[60:63]
    v_mfma_f32_16x16x32_bf16 v[76:79], v[28:31], v[120:123], v[76:79]
    v_mfma_f32_16x16x32_bf16 v[64:67], v[116:119], v[32:35], v[64:67]
    v_mfma_f32_16x16x32_bf16 v[80:83], v[32:35], v[120:123], v[80:83]
    s_waitcnt vmcnt(0) lgkmcnt(0)
    v_mfma_f32_16x16x32_bf16 v[52:55], v[124:127], v[36:39], v[52:55]
    v_mfma_f32_16x16x32_bf16 v[68:71], v[36:39], v[128:131], v[68:71]
    v_mfma_f32_16x16x32_bf16 v[56:59], v[124:127], v[40:43], v[56:59]
    v_mfma_f32_16x16x32_bf16 v[72:75], v[40:43], v[128:131], v[72:75]
    v_mfma_f32_16x16x32_bf16 v[60:63], v[124:127], v[44:47], v[60:63]
    v_mfma_f32_16x16x32_bf16 v[76:79], v[44:47], v[128:131], v[76:79]
    v_mfma_f32_16x16x32_bf16 v[64:67], v[124:127], v[48:51], v[64:67]
    v_mfma_f32_16x16x32_bf16 v[80:83], v[48:51], v[128:131], v[80:83]
    s_mov_b32 s40, 0x3fb8aa3b
    s_mov_b32 s41, 0x3fb8aa3b
    s_mov_b32 s42, 0x358637bd
    s_mov_b32 s43, 0x358637bd
    v_pk_mul_f32 v[12:13], v[68:69], s[40:41]
    v_pk_mul_f32 v[14:15], v[70:71], s[40:41]
    v_exp_f32 v12, v12 clamp
    v_exp_f32 v13, v13 clamp
    v_exp_f32 v14, v14 clamp
    v_exp_f32 v15, v15 clamp
    v_max_f32 v16, 0, v68
    v_max_f32 v17, 0, v69
    v_max_f32 v18, 0, v70
    v_max_f32 v19, 0, v71
    v_pk_add_f32 v[12:13], v[12:13], s[42:43]
    v_pk_add_f32 v[14:15], v[14:15], s[42:43]
    v_pk_add_f32 v[84:85], v[12:13], v[16:17]
    v_pk_add_f32 v[86:87], v[14:15], v[18:19]
    v_pk_mul_f32 v[12:13], v[72:73], s[40:41]
    v_pk_mul_f32 v[14:15], v[74:75], s[40:41]
    v_exp_f32 v12, v12 clamp
    v_exp_f32 v13, v13 clamp
    v_exp_f32 v14, v14 clamp
    v_exp_f32 v15, v15 clamp
    v_max_f32 v16, 0, v72
    v_max_f32 v17, 0, v73
    v_max_f32 v18, 0, v74
    v_max_f32 v19, 0, v75
    v_pk_add_f32 v[12:13], v[12:13], s[42:43]
    v_pk_add_f32 v[14:15], v[14:15], s[42:43]
    v_pk_add_f32 v[88:89], v[12:13], v[16:17]
    v_pk_add_f32 v[90:91], v[14:15], v[18:19]
    v_pk_mul_f32 v[12:13], v[76:77], s[40:41]
    v_pk_mul_f32 v[14:15], v[78:79], s[40:41]
    v_exp_f32 v12, v12 clamp
    v_exp_f32 v13, v13 clamp
    v_exp_f32 v14, v14 clamp
    v_exp_f32 v15, v15 clamp
    v_max_f32 v16, 0, v76
    v_max_f32 v17, 0, v77
    v_max_f32 v18, 0, v78
    v_max_f32 v19, 0, v79
    v_pk_add_f32 v[12:13], v[12:13], s[42:43]
    v_pk_add_f32 v[14:15], v[14:15], s[42:43]
    v_pk_add_f32 v[92:93], v[12:13], v[16:17]
    v_pk_add_f32 v[94:95], v[14:15], v[18:19]
    v_pk_mul_f32 v[12:13], v[80:81], s[40:41]
    v_pk_mul_f32 v[14:15], v[82:83], s[40:41]
    v_exp_f32 v12, v12 clamp
    v_exp_f32 v13, v13 clamp
    v_exp_f32 v14, v14 clamp
    v_exp_f32 v15, v15 clamp
    v_max_f32 v16, 0, v80
    v_max_f32 v17, 0, v81
    v_max_f32 v18, 0, v82
    v_max_f32 v19, 0, v83
    v_pk_add_f32 v[12:13], v[12:13], s[42:43]
    v_pk_add_f32 v[14:15], v[14:15], s[42:43]
    v_pk_add_f32 v[96:97], v[12:13], v[16:17]
    v_pk_add_f32 v[98:99], v[14:15], v[18:19]
    s_mov_b32 s52, 0x0f0f0f0f
    s_mov_b32 s53, 0x0f0f0f0f
    v_cndmask_b32 v68, v68, v84, s[52:53]
    v_cndmask_b32 v69, v69, v85, s[52:53]
    v_cndmask_b32 v70, v70, v86, s[52:53]
    v_cndmask_b32 v71, v71, v87, s[52:53]
    v_cndmask_b32 v72, v72, v88, s[52:53]
    v_cndmask_b32 v73, v73, v89, s[52:53]
    v_cndmask_b32 v74, v74, v90, s[52:53]
    v_cndmask_b32 v75, v75, v91, s[52:53]
    v_cndmask_b32 v76, v76, v92, s[52:53]
    v_cndmask_b32 v77, v77, v93, s[52:53]
    v_cndmask_b32 v78, v78, v94, s[52:53]
    v_cndmask_b32 v79, v79, v95, s[52:53]
    v_cndmask_b32 v80, v80, v96, s[52:53]
    v_cndmask_b32 v81, v81, v97, s[52:53]
    v_cndmask_b32 v82, v82, v98, s[52:53]
    v_cndmask_b32 v83, v83, v99, s[52:53]
    v_cvt_pk_bf16_f32 v20, v68, v69
    v_cvt_pk_bf16_f32 v21, v70, v71
    v_cvt_pk_bf16_f32 v22, v72, v73
    v_cvt_pk_bf16_f32 v23, v74, v75
    v_cvt_pk_bf16_f32 v24, v76, v77
    v_cvt_pk_bf16_f32 v25, v78, v79
    v_cvt_pk_bf16_f32 v26, v80, v81
    v_cvt_pk_bf16_f32 v27, v82, v83
    s_lshl_b32 s31, s44, 11
    s_add_u32 s31, s31, 147520
    v_add_u32 v12, s31, v3
    ds_write_b128 v12, v[20:23]
    ds_write_b128 v12, v[24:27] offset:1024
    s_lshl_b32 s31, s44, 2
    s_add_u32 s31, s31, 147456
    v_mov_b32 v13, s31
    v_mov_b32 v14, 1
    s_waitcnt lgkmcnt(0)
    ds_write_b32 v13, v14
    v_pk_mul_f32 v[12:13], v[52:53], s[40:41]
    v_pk_mul_f32 v[14:15], v[54:55], s[40:41]
    v_exp_f32 v12, v12 clamp
    v_exp_f32 v13, v13 clamp
    v_exp_f32 v14, v14 clamp
    v_exp_f32 v15, v15 clamp
    v_max_f32 v16, 0, v52
    v_max_f32 v17, 0, v53
    v_max_f32 v18, 0, v54
    v_max_f32 v19, 0, v55
    v_pk_add_f32 v[12:13], v[12:13], s[42:43]
    v_pk_add_f32 v[14:15], v[14:15], s[42:43]
    v_pk_add_f32 v[52:53], v[12:13], v[16:17]
    v_pk_add_f32 v[54:55], v[14:15], v[18:19]
    v_pk_mul_f32 v[12:13], v[56:57], s[40:41]
    v_pk_mul_f32 v[14:15], v[58:59], s[40:41]
    v_exp_f32 v12, v12 clamp
    v_exp_f32 v13, v13 clamp
    v_exp_f32 v14, v14 clamp
    v_exp_f32 v15, v15 clamp
    v_max_f32 v16, 0, v56
    v_max_f32 v17, 0, v57
    v_max_f32 v18, 0, v58
    v_max_f32 v19, 0, v59
    v_pk_add_f32 v[12:13], v[12:13], s[42:43]
    v_pk_add_f32 v[14:15], v[14:15], s[42:43]
    v_pk_add_f32 v[56:57], v[12:13], v[16:17]
    v_pk_add_f32 v[58:59], v[14:15], v[18:19]
    v_pk_mul_f32 v[12:13], v[60:61], s[40:41]
    v_pk_mul_f32 v[14:15], v[62:63], s[40:41]
    v_exp_f32 v12, v12 clamp
    v_exp_f32 v13, v13 clamp
    v_exp_f32 v14, v14 clamp
    v_exp_f32 v15, v15 clamp
    v_max_f32 v16, 0, v60
    v_max_f32 v17, 0, v61
    v_max_f32 v18, 0, v62
    v_max_f32 v19, 0, v63
    v_pk_add_f32 v[12:13], v[12:13], s[42:43]
    v_pk_add_f32 v[14:15], v[14:15], s[42:43]
    v_pk_add_f32 v[60:61], v[12:13], v[16:17]
    v_pk_add_f32 v[62:63], v[14:15], v[18:19]
    v_pk_mul_f32 v[12:13], v[64:65], s[40:41]
    v_pk_mul_f32 v[14:15], v[66:67], s[40:41]
    v_exp_f32 v12, v12 clamp
    v_exp_f32 v13, v13 clamp
    v_exp_f32 v14, v14 clamp
    v_exp_f32 v15, v15 clamp
    v_max_f32 v16, 0, v64
    v_max_f32 v17, 0, v65
    v_max_f32 v18, 0, v66
    v_max_f32 v19, 0, v67
    v_pk_add_f32 v[12:13], v[12:13], s[42:43]
    v_pk_add_f32 v[14:15], v[14:15], s[42:43]
    v_pk_add_f32 v[64:65], v[12:13], v[16:17]
    v_pk_add_f32 v[66:67], v[14:15], v[18:19]
    v_cvt_pk_bf16_f32 v28, v52, v53
    v_cvt_pk_bf16_f32 v29, v54, v55
    v_cvt_pk_bf16_f32 v30, v56, v57
    v_cvt_pk_bf16_f32 v31, v58, v59
    v_cvt_pk_bf16_f32 v32, v60, v61
    v_cvt_pk_bf16_f32 v33, v62, v63
    v_cvt_pk_bf16_f32 v34, v64, v65
    v_cvt_pk_bf16_f32 v35, v66, v67
    s_mul_i32 s32, s44, 2304
    s_add_u32 s32, s32, 73728
    v_and_b32 v12, 15, v1
    v_lshrrev_b32 v13, 4, v1
    v_mul_u32_u24 v14, 36, v12
    v_add_u32 v14, s32, v14
    v_lshl_add_u32 v14, v13, 3, v14
    v_add_u32 v15, 1152, v14
    ds_write2_b32 v14, v28, v29 offset0:0 offset1:1
    ds_write2_b32 v14, v30, v31 offset0:144 offset1:145
    ds_write2_b32 v15, v32, v33 offset0:0 offset1:1
    ds_write2_b32 v15, v34, v35 offset0:144 offset1:145
    s_and_b32 s52, s44, 1
    s_lshl_b32 s52, s52, 1
    s_lshl_b32 s53, 0x03000300, s52
    s_mov_b32 s62, s53
    s_mov_b32 s63, s53
    s_add_u32 s52, s52, 8
    v_subrev_u32 v16, s52, v12
    v_lshlrev_b32 v16, 1, v16
    v_mul_u32_u24 v17, 144, v13
    v_add3_u32 v16, v16, v17, s32
    s_mov_b64 exec, s[62:63]
    ds_write_b16 v16, v20 offset:32
    ds_write_b16_d16_hi v16, v20 offset:68
    ds_write_b16 v16, v21 offset:104
    ds_write_b16_d16_hi v16, v21 offset:140
    ds_write_b16 v16, v22 offset:608
    ds_write_b16_d16_hi v16, v22 offset:644
    ds_write_b16 v16, v23 offset:680
    ds_write_b16_d16_hi v16, v23 offset:716
    ds_write_b16 v16, v24 offset:1184
    ds_write_b16_d16_hi v16, v24 offset:1220
    ds_write_b16 v16, v25 offset:1256
    ds_write_b16_d16_hi v16, v25 offset:1292
    ds_write_b16 v16, v26 offset:1760
    ds_write_b16_d16_hi v16, v26 offset:1796
    ds_write_b16 v16, v27 offset:1832
    ds_write_b16_d16_hi v16, v27 offset:1868
    s_mov_b64 exec, -1
    v_add_u32 v17, s32, v3
    s_waitcnt lgkmcnt(0)
    ds_read_b128 v[84:87], v17 offset:0
    ds_read_b128 v[88:91], v17 offset:1024
    ds_read_b128 v[92:95], v17 offset:2048
    s_lshl_b32 s31, s48, 2
    s_add_u32 s31, s31, s44
    s_mul_i32 s31, s31, 73728
    s_mul_i32 s32, s49, 2304
    s_add_u32 s31, s31, s32
    s_add_u32 s31, s31, 0x100000
    s_waitcnt lgkmcnt(0)
    buffer_store_dwordx4 v[84:87], v3, s[16:19], s31 offen offset:0 sc1
    buffer_store_dwordx4 v[88:91], v3, s[16:19], s31 offen offset:1024 sc1
    s_mov_b64 exec, s[64:65]
    buffer_store_dwordx4 v[92:95], v3, s[16:19], s31 offen offset:2048 sc1
    s_mov_b64 exec, -1
    s_setprio 0
    s_branch L_p1_end
L_p0_help:
    v_lshlrev_b32 v12, 2, v1
    v_add_u32 v12, 147456, v12
    v_mov_b32 v13, 0
    s_mov_b64 exec, 0x1f
    ds_write_b32 v12, v13
    s_mov_b64 exec, -1
    s_mov_b32 s73, 0
    s_cmp_ge_u32 s2, 144
    s_cbranch_scc1 L_p0_small
    s_mul_i32 s43, s2, 3641
    s_lshr_b32 s43, s43, 16
    s_mul_i32 s42, s43, 18
    s_sub_u32 s42, s2, s42
    s_sub_u32 s44, s3, 8
    s_lshl_b32 s40, s43, 2
    s_add_u32 s40, s40, s44
    s_mul_i32 s40, s40, 18
    s_add_u32 s40, s40, s42
    s_mul_i32 s45, s42, 110592
    s_lshl_b32 s46, s43, 7
    s_add_u32 s45, s45, s46
    s_mul_i32 s46, s44, 27648
    s_add_u32 s45, s45, s46
    s_mul_i32 s47, s44, 6144
    s_add_u32 s47, s47, 90112
    v_add_u32 v12, 0, v1
    v_mul_u32_u24 v13, 171, v12
    v_lshrrev_b32 v13, 13, v13
    v_mul_u32_u24 v14, 48, v13
    v_sub_u32 v14, v12, v14
    v_lshrrev_b32 v15, 4, v14
    v_and_b32 v16, 15, v14
    v_mul_u32_u24 v13, 3456, v13
    v_lshl_add_u32 v13, v16, 4, v13
    v_add_u32 v15, 1, v15
    v_cmp_eq_u32 vcc, 3, v15
    s_nop 1
    v_cndmask_b32 v15, v15, 0, vcc
    v_mul_u32_u24 v15, 1152, v15
    v_add_u32 v20, v13, v15
    v_add_u32 v12, 64, v1
    v_mul_u32_u24 v13, 171, v12
    v_lshrrev_b32 v13, 13, v13
    v_mul_u32_u24 v14, 48, v13
    v_sub_u32 v14, v12, v14
    v_lshrrev_b32 v15, 4, v14
    v_and_b32 v16, 15, v14
    v_mul_u32_u24 v13, 3456, v13
    v_lshl_add_u32 v13, v16, 4, v13
    v_add_u32 v15, 1, v15
    v_cmp_eq_u32 vcc, 3, v15
    s_nop 1
    v_cndmask_b32 v15, v15, 0, vcc
    v_mul_u32_u24 v15, 1152, v15
    v_add_u32 v21, v13, v15
    v_add_u32 v12, 128, v1
    v_mul_u32_u24 v13, 171, v12
    v_lshrrev_b32 v13, 13, v13
    v_mul_u32_u24 v14, 48, v13
    v_sub_u32 v14, v12, v14
    v_lshrrev_b32 v15, 4, v14
    v_and_b32 v16, 15, v14
    v_mul_u32_u24 v13, 3456, v13
    v_lshl_add_u32 v13, v16, 4, v13
    v_add_u32 v15, 1, v15
    v_cmp_eq_u32 vcc, 3, v15
    s_nop 1
    v_cndmask_b32 v15, v15, 0, vcc
    v_mul_u32_u24 v15, 1152, v15
    v_add_u32 v22, v13, v15
    s_add_u32 m0, s47, 0
    s_nop 0
    buffer_load_dwordx4 v20, s[12:15], s45 offen lds
    s_add_u32 m0, s47, 1024
    s_nop 0
    buffer_load_dwordx4 v21, s[12:15], s45 offen lds
    s_add_u32 m0, s47, 2048
    s_nop 0
    buffer_load_dwordx4 v22, s[12:15], s45 offen lds
    s_add_u32 s45, s45, 13824
    s_add_u32 m0, s47, 3072
    s_nop 0
    buffer_load_dwordx4 v20, s[12:15], s45 offen lds
    s_add_u32 m0, s47, 4096
    s_nop 0
    buffer_load_dwordx4 v21, s[12:15], s45 offen lds
    s_add_u32 m0, s47, 5120
    s_nop 0
    buffer_load_dwordx4 v22, s[12:15], s45 offen lds
    s_lshl_b32 s46, s44, 3
    s_lshr_b32 s48, 0x10080800, s46
    s_and_b32 s48, s48, 0xff
    s_lshr_b32 s49, 0x08280020, s46
    s_and_b32 s49, s49, 0xff
    s_lshl_b32 s50, s43, 4
    s_lshl_b32 s51, s44, 5
    s_add_u32 s50, s50, s51
    s_add_u32 s50, s50, 90112
    v_lshrrev_b32 v12, 4, v1
    v_lshlrev_b32 v12, 3, v12
    v_bfe_u32 v13, v1, 2, 2
    v_add_u32 v12, v12, v13
    v_mul_u32_u24 v12, 768, v12
    v_add_u32 v12, s50, v12
    v_and_b32 v13, 3, v1
    v_lshl_add_u32 v14, v13, 3, v12
    v_add_u32 v14, s48, v14
    v_min_u32 v13, 2, v13
    v_lshlrev_b32 v13, 8, v13
    v_add3_u32 v15, v12, v13, s49
    s_lshl_b32 s46, s40, 12
    s_add_u32 s46, s46, 0x1720000
    v_lshlrev_b32 v16, 4, v1
    s_waitcnt vmcnt(0)
    s_waitcnt lgkmcnt(0)
    s_mul_i32 s28, s28, 1664525
    s_add_u32 s28, s28, 1013904223
    s_barrier
    ds_read_b64_tr_b16 v[28:29], v14 offset:0
    ds_read_b64_tr_b16 v[30:31], v14 offset:3072
    ds_read_b64_tr_b16 v[32:33], v14 offset:256
    ds_read_b64_tr_b16 v[34:35], v14 offset:3328
    ds_read_b64_tr_b16 v[36:37], v14 offset:512
    ds_read_b64_tr_b16 v[38:39], v14 offset:3584
    ds_read_b64_tr_b16 v[40:41], v15
    ds_read_b64_tr_b16 v[42:43], v15 offset:3072
    s_mov_b32 s50, 0xf000f000
    s_mov_b32 s51, 0xf000f000
    s_waitcnt lgkmcnt(0)
    v_cndmask_b32 v40, v40, 0, s[50:51]
    v_cndmask_b32 v41, v41, 0, s[50:51]
    v_cndmask_b32 v42, v42, 0, s[50:51]
    v_cndmask_b32 v43, v43, 0, s[50:51]
    buffer_store_dwordx4 v[28:31], v16, s[16:19], s46 offen offset:0 sc1
    buffer_store_dwordx4 v[32:35], v16, s[16:19], s46 offen offset:1024 sc1
    buffer_store_dwordx4 v[36:39], v16, s[16:19], s46 offen offset:2048 sc1
    buffer_store_dwordx4 v[40:43], v16, s[16:19], s46 offen offset:3072 sc1
    s_waitcnt vmcnt(0)
    v_mov_b32 v12, 147472
    v_mov_b32 v13, 1
    s_mov_b64 exec, 1
    ds_add_rtn_u32 v14, v12, v13
    s_waitcnt lgkmcnt(0)
    v_readfirstlane_b32 s31, v14
    s_mov_b64 exec, -1
    s_cmp_eq_u32 s31, 3
    s_cbranch_scc0 Lha_13
    s_lshl_b32 s31, s2, 7
    s_mov_b64 exec, 1
    v_mov_b32 v12, s28
    v_mov_b32 v13, 0x8000
    buffer_store_dword v12, v13, s[16:19], s31 offen sc1
    s_mov_b64 exec, -1
Lha_13:
    s_branch L_p0_jx
L_p0_small:
    s_waitcnt lgkmcnt(0)
    s_mul_i32 s28, s28, 1664525
    s_add_u32 s28, s28, 1013904223
    s_cmp_eq_u32 s3, 8
    s_cbranch_scc0 L_p0_n8
    s_getpc_b64 s[32:33]
L_pc_ref:
    s_sub_u32 s32, s32, L_pc_ref-sequential_preLN__linear_attn_block__mixer_s_mlp__prompt_kernel
    s_subb_u32 s33, s33, 0
    s_sub_u32 s34, s30, 18
    s_lshl_b32 s34, s34, 12
    v_lshlrev_b32 v12, 6, v1
    v_add_u32 v12, s34, v12
    v_min_u32 v12, L_code_end-sequential_preLN__linear_attn_block__mixer_s_mlp__prompt_kernel-4, v12
    global_load_dword v160, v12, s[32:33]
    s_cmp_lt_u32 s2, 248
    s_cbranch_scc1 Lz_14
    v_mov_b32 v32, 0
    v_mov_b32 v33, 0
    v_mov_b32 v34, 0
    v_mov_b32 v35, 0
    v_lshlrev_b32 v12, 4, v1
    s_sub_u32 s33, s2, 248
    s_mul_i32 s31, s33, 6144
    s_add_u32 s31, s31, 0x30000
    buffer_store_dwordx4 v[32:35], v12, s[16:19], s31 offen offset:0 sc1
    buffer_store_dwordx4 v[32:35], v12, s[16:19], s31 offen offset:1024 sc1
    buffer_store_dwordx4 v[32:35], v12, s[16:19], s31 offen offset:2048 sc1
    buffer_store_dwordx4 v[32:35], v12, s[16:19], s31 offen offset:3072 sc1
    s_add_u32 s31, s31, 4096
    buffer_store_dwordx4 v[32:35], v12, s[16:19], s31 offen offset:0 sc1
    buffer_store_dwordx4 v[32:35], v12, s[16:19], s31 offen offset:1024 sc1
    s_lshl_b32 s31, s33, 7
    s_add_u32 s31, s31, 0x3c000
    s_mov_b64 exec, 1
    v_mov_b32 v12, 0
    buffer_store_dword v32, v12, s[16:19], s31 offen sc1
    buffer_store_dword v32, v12, s[16:19], s31 offen offset:1024 sc1
    buffer_store_dword v32, v12, s[16:19], s31 offen offset:2048 sc1
    buffer_store_dword v32, v12, s[16:19], s31 offen offset:3072 sc1
    s_mov_b64 exec, -1
    s_waitcnt vmcnt(0)
Lz_14:
    s_branch L_p0_sb
L_p0_n8:
    s_cmp_eq_u32 s3, 11
    s_cbranch_scc0 L_p0_n11
    s_mov_b32 s50, 0
    s_mov_b32 s49, 0
    s_mov_b32 s42, 1152
    s_load_dwordx2 s[32:33], s[0:1], 16
    s_load_dwordx4 s[36:39], s[0:1], 32
    s_sub_u32 s60, s2, 144
    s_mul_i32 s58, s60, 19
    s_lshr_b32 s58, s58, 9
    s_mul_i32 s59, s58, 27
    s_sub_u32 s59, s60, s59
    s_mul_i32 s52, s59, 57
    s_lshr_b32 s52, s52, 9
    s_mul_i32 s53, s52, 9
    s_sub_u32 s53, s59, s53
    s_cmp_lt_u32 s60, 81
    s_cselect_b32 s50, 1, 0
    s_waitcnt lgkmcnt(0)
    s_cmp_eq_u32 s58, 1
    s_cselect_b32 s32, s36, s32
    s_cselect_b32 s33, s37, s33
    s_cmp_eq_u32 s58, 2
    s_cselect_b32 s32, s38, s32
    s_cselect_b32 s33, s39, s33
    s_mov_b32 s24, s32
    s_mov_b32 s25, s33
    s_mov_b32 s26, 0xa2000
    s_mov_b32 s27, 0x20000
    s_mul_i32 s43, s52, 221184
    s_lshl_b32 s54, s53, 7
    s_add_u32 s43, s43, s54
    s_lshl_b32 s54, s53, 2
    s_add_u32 s54, s54, 0
    s_mul_i32 s54, s54, 18
    s_mul_i32 s55, s52, 6
    s_add_u32 s54, s54, s55
    s_lshl_b32 s54, s54, 10
    s_mul_i32 s55, s58, 663552
    s_add_u32 s54, s54, s55
    s_add_u32 s44, s54, 0xa00000
    s_lshl_b32 s54, s53, 2
    s_add_u32 s54, s54, 1
    s_mul_i32 s54, s54, 18
    s_mul_i32 s55, s52, 6
    s_add_u32 s54, s54, s55
    s_lshl_b32 s54, s54, 10
    s_mul_i32 s55, s58, 663552
    s_add_u32 s54, s54, s55
    s_add_u32 s45, s54, 0xa00000
    s_lshl_b32 s54, s53, 2
    s_add_u32 s54, s54, 2
    s_mul_i32 s54, s54, 18
    s_mul_i32 s55, s52, 6
    s_add_u32 s54, s54, s55
    s_lshl_b32 s54, s54, 10
    s_mul_i32 s55, s58, 663552
    s_add_u32 s54, s54, s55
    s_add_u32 s46, s54, 0xa00000
    s_lshl_b32 s54, s53, 2
    s_add_u32 s54, s54, 3
    s_mul_i32 s54, s54, 18
    s_mul_i32 s55, s52, 6
    s_add_u32 s54, s54, s55
    s_lshl_b32 s54, s54, 10
    s_mul_i32 s55, s58, 663552
    s_add_u32 s54, s54, s55
    s_add_u32 s47, s54, 0xa00000
    s_mov_b32 s48, 1024
    s_mul_i32 s54, s52, 2304
    s_lshl_b32 s55, s53, 8
    s_add_u32 s54, s54, s55
    s_add_u32 s54, s54, 0x60000
    s_cmp_eq_u32 s58, 1
    s_cselect_b32 s49, s54, 0
    s_mov_b32 s51, 114688
    s_mov_b32 s73, s50
    s_branch L_p0_sb
L_p0_n11:
    s_sub_u32 s31, s3, 9
    s_mul_i32 s31, s31, 4608
    s_add_u32 s72, s31, 119296
    s_mov_b32 s50, 0
    s_mov_b32 s49, 0
    s_mov_b32 s42, 1152
    s_load_dwordx2 s[4:5], s[0:1], 48
    s_sub_u32 s59, s2, 144
    s_lshl_b32 s59, s59, 1
    s_add_u32 s59, s59, s3
    s_sub_u32 s59, s59, 9
    s_mul_i32 s58, s59, 19
    s_lshr_b32 s58, s58, 9
    s_mul_i32 s60, s58, 27
    s_sub_u32 s60, s59, s60
    s_cmp_lt_u32 s59, 216
    s_cselect_b32 s50, 1, 0
    s_mul_i32 s52, s60, 57
    s_lshr_b32 s52, s52, 9
    s_mul_i32 s53, s52, 9
    s_sub_u32 s53, s60, s53
    s_lshl_b32 s54, s53, 2
    s_add_u32 s54, s54, 0
    s_mul_i32 s55, s54, 43
    s_lshr_b32 s55, s55, 7
    s_mul_i32 s56, s55, 3
    s_sub_u32 s56, s54, s56
    s_mul_i32 s57, s58, 12
    s_add_u32 s57, s57, s55
    s_mul_i32 s57, s57, 55296
    s_lshl_b32 s56, s56, 10
    s_add_u32 s57, s57, s56
    s_mul_i32 s56, s52, 18432
    s_add_u32 s57, s57, s56
    s_add_u32 s44, s57, 0xc00000
    s_lshl_b32 s54, s53, 2
    s_add_u32 s54, s54, 1
    s_mul_i32 s55, s54, 43
    s_lshr_b32 s55, s55, 7
    s_mul_i32 s56, s55, 3
    s_sub_u32 s56, s54, s56
    s_mul_i32 s57, s58, 12
    s_add_u32 s57, s57, s55
    s_mul_i32 s57, s57, 55296
    s_lshl_b32 s56, s56, 10
    s_add_u32 s57, s57, s56
    s_mul_i32 s56, s52, 18432
    s_add_u32 s57, s57, s56
    s_add_u32 s45, s57, 0xc00000
    s_lshl_b32 s54, s53, 2
    s_add_u32 s54, s54, 2
    s_mul_i32 s55, s54, 43
    s_lshr_b32 s55, s55, 7
    s_mul_i32 s56, s55, 3
    s_sub_u32 s56, s54, s56
    s_mul_i32 s57, s58, 12
    s_add_u32 s57, s57, s55
    s_mul_i32 s57, s57, 55296
    s_lshl_b32 s56, s56, 10
    s_add_u32 s57, s57, s56
    s_mul_i32 s56, s52, 18432
    s_add_u32 s57, s57, s56
    s_add_u32 s46, s57, 0xc00000
    s_lshl_b32 s54, s53, 2
    s_add_u32 s54, s54, 3
    s_mul_i32 s55, s54, 43
    s_lshr_b32 s55, s55, 7
    s_mul_i32 s56, s55, 3
    s_sub_u32 s56, s54, s56
    s_mul_i32 s57, s58, 12
    s_add_u32 s57, s57, s55
    s_mul_i32 s57, s57, 55296
    s_lshl_b32 s56, s56, 10
    s_add_u32 s57, s57, s56
    s_mul_i32 s56, s52, 18432
    s_add_u32 s57, s57, s56
    s_add_u32 s47, s57, 0xc00000
    s_mov_b32 s48, 3072
    s_waitcnt lgkmcnt(0)
    s_mov_b32 s24, s4
    s_mov_b32 s25, s5
    s_mov_b32 s26, 0x510000
    s_mov_b32 s27, 0x20000
    s_mov_b32 s42, 9216
    s_mul_i32 s43, s52, 1769472
    s_mul_i32 s54, s58, 1152
    s_add_u32 s43, s43, s54
    s_lshl_b32 s54, s53, 7
    s_add_u32 s43, s43, s54
    s_mul_i32 s49, s52, 18432
    s_mul_i32 s54, s58, 2304
    s_add_u32 s49, s49, s54
    s_lshl_b32 s54, s53, 8
    s_add_u32 s49, s49, s54
    s_add_u32 s49, s49, 0x62000
    s_mov_b32 s51, 0
    s_mov_b32 s51, s72
    s_mov_b32 s73, s50
L_p0_sb:
    s_barrier
    v_mov_b32 v12, 147472
    v_mov_b32 v13, 1
    s_mov_b64 exec, 1
    ds_add_rtn_u32 v14, v12, v13
    s_waitcnt lgkmcnt(0)
    v_readfirstlane_b32 s31, v14
    s_mov_b64 exec, -1
    s_cmp_eq_u32 s31, 3
    s_cbranch_scc0 Lha_15
    s_lshl_b32 s31, s2, 7
    s_mov_b64 exec, 1
    v_mov_b32 v12, s28
    v_mov_b32 v13, 0x8000
    buffer_store_dword v12, v13, s[16:19], s31 offen sc1
    s_mov_b64 exec, -1
Lha_15:
    s_cmp_eq_u32 s73, 0
    s_cbranch_scc1 L_p0_jx
    v_lshrrev_b32 v12, 3, v1
    v_mul_lo_u32 v12, v12, s42
    v_and_b32 v13, 7, v1
    v_lshl_add_u32 v140, v13, 4, v12
    s_mov_b32 s52, s43
    s_lshl_b32 s53, s42, 3
    buffer_load_dwordx4 v[44:47], v140, s[24:27], s52 offen
    s_add_u32 s52, s52, s53
    buffer_load_dwordx4 v[48:51], v140, s[24:27], s52 offen
    s_add_u32 s52, s52, s53
    buffer_load_dwordx4 v[52:55], v140, s[24:27], s52 offen
    s_add_u32 s52, s52, s53
    buffer_load_dwordx4 v[56:59], v140, s[24:27], s52 offen
    s_add_u32 s52, s52, s53
    buffer_load_dwordx4 v[60:63], v140, s[24:27], s52 offen
    s_add_u32 s52, s52, s53
    buffer_load_dwordx4 v[64:67], v140, s[24:27], s52 offen
    s_add_u32 s52, s52, s53
    buffer_load_dwordx4 v[68:71], v140, s[24:27], s52 offen
    s_add_u32 s52, s52, s53
    buffer_load_dwordx4 v[72:75], v140, s[24:27], s52 offen
    s_add_u32 s52, s52, s53
    buffer_load_dwordx4 v[76:79], v140, s[24:27], s52 offen
    s_add_u32 s52, s52, s53
    buffer_load_dwordx4 v[80:83], v140, s[24:27], s52 offen
    s_add_u32 s52, s52, s53
    buffer_load_dwordx4 v[84:87], v140, s[24:27], s52 offen
    s_add_u32 s52, s52, s53
    buffer_load_dwordx4 v[88:91], v140, s[24:27], s52 offen
    s_add_u32 s52, s52, s53
    buffer_load_dwordx4 v[92:95], v140, s[24:27], s52 offen
    s_add_u32 s52, s52, s53
    buffer_load_dwordx4 v[96:99], v140, s[24:27], s52 offen
    s_add_u32 s52, s52, s53
    buffer_load_dwordx4 v[100:103], v140, s[24:27], s52 offen
    s_add_u32 s52, s52, s53
    buffer_load_dwordx4 v[104:107], v140, s[24:27], s52 offen
    s_add_u32 s52, s52, s53
    buffer_load_dwordx4 v[108:111], v140, s[24:27], s52 offen
    s_add_u32 s52, s52, s53
    buffer_load_dwordx4 v[112:115], v140, s[24:27], s52 offen
    s_add_u32 s52, s52, s53
    buffer_load_dwordx4 v[116:119], v140, s[24:27], s52 offen
    s_add_u32 s52, s52, s53
    buffer_load_dwordx4 v[120:123], v140, s[24:27], s52 offen
    s_add_u32 s52, s52, s53
    buffer_load_dwordx4 v[124:127], v140, s[24:27], s52 offen
    s_add_u32 s52, s52, s53
    buffer_load_dwordx4 v[128:131], v140, s[24:27], s52 offen
    s_add_u32 s52, s52, s53
    buffer_load_dwordx4 v[132:135], v140, s[24:27], s52 offen
    s_add_u32 s52, s52, s53
    buffer_load_dwordx4 v[136:139], v140, s[24:27], s52 offen
    s_add_u32 s52, s52, s53
    s_cmp_eq_u32 s3, 11
    s_cbranch_scc0 L_p0_jx
    v_lshrrev_b32 v12, 3, v1
    v_mul_u32_u24 v12, 144, v12
    v_and_b32 v13, 7, v1
    v_lshl_add_u32 v141, v13, 4, v12
    v_add_u32 v141, s51, v141
    v_lshrrev_b32 v12, 4, v1
    v_lshlrev_b32 v12, 3, v12
    v_bfe_u32 v13, v1, 2, 2
    v_add_u32 v12, v12, v13
    v_mul_u32_u24 v12, 144, v12
    v_and_b32 v13, 3, v1
    v_lshl_add_u32 v142, v13, 3, v12
    v_add_u32 v142, s51, v142
    v_mov_b32 v36, 0
    v_mov_b32 v37, 0
    v_mov_b32 v38, 0
    v_mov_b32 v39, 0
    s_mov_b32 s54, 0x3f803f80
    s_waitcnt vmcnt(20)
    ds_write_b128 v141, v[44:47] offset:0
    ds_write_b128 v141, v[48:51] offset:1152
    ds_write_b128 v141, v[52:55] offset:2304
    ds_write_b128 v141, v[56:59] offset:3456
    s_waitcnt lgkmcnt(0)
    ds_read_b64_tr_b16 v[44:45], v142 offset:0
    ds_read_b64_tr_b16 v[46:47], v142 offset:576
    ds_read_b64_tr_b16 v[48:49], v142 offset:32
    ds_read_b64_tr_b16 v[50:51], v142 offset:608
    ds_read_b64_tr_b16 v[52:53], v142 offset:64
    ds_read_b64_tr_b16 v[54:55], v142 offset:640
    ds_read_b64_tr_b16 v[56:57], v142 offset:96
    ds_read_b64_tr_b16 v[58:59], v142 offset:672
    s_waitcnt lgkmcnt(0)
    v_dot2_f32_bf16 v36, v44, s54, v36
    v_dot2_f32_bf16 v37, v48, s54, v37
    v_dot2_f32_bf16 v38, v52, s54, v38
    v_dot2_f32_bf16 v39, v56, s54, v39
    v_dot2_f32_bf16 v36, v45, s54, v36
    v_dot2_f32_bf16 v37, v49, s54, v37
    v_dot2_f32_bf16 v38, v53, s54, v38
    v_dot2_f32_bf16 v39, v57, s54, v39
    v_dot2_f32_bf16 v36, v46, s54, v36
    v_dot2_f32_bf16 v37, v50, s54, v37
    v_dot2_f32_bf16 v38, v54, s54, v38
    v_dot2_f32_bf16 v39, v58, s54, v39
    v_dot2_f32_bf16 v36, v47, s54, v36
    v_dot2_f32_bf16 v37, v51, s54, v37
    v_dot2_f32_bf16 v38, v55, s54, v38
    v_dot2_f32_bf16 v39, v59, s54, v39
    s_waitcnt vmcnt(16)
    ds_write_b128 v141, v[60:63] offset:0
    ds_write_b128 v141, v[64:67] offset:1152
    ds_write_b128 v141, v[68:71] offset:2304
    ds_write_b128 v141, v[72:75] offset:3456
    s_waitcnt lgkmcnt(0)
    ds_read_b64_tr_b16 v[60:61], v142 offset:0
    ds_read_b64_tr_b16 v[62:63], v142 offset:576
    ds_read_b64_tr_b16 v[64:65], v142 offset:32
    ds_read_b64_tr_b16 v[66:67], v142 offset:608
    ds_read_b64_tr_b16 v[68:69], v142 offset:64
    ds_read_b64_tr_b16 v[70:71], v142 offset:640
    ds_read_b64_tr_b16 v[72:73], v142 offset:96
    ds_read_b64_tr_b16 v[74:75], v142 offset:672
    s_waitcnt lgkmcnt(0)
    v_dot2_f32_bf16 v36, v60, s54, v36
    v_dot2_f32_bf16 v37, v64, s54, v37
    v_dot2_f32_bf16 v38, v68, s54, v38
    v_dot2_f32_bf16 v39, v72, s54, v39
    v_dot2_f32_bf16 v36, v61, s54, v36
    v_dot2_f32_bf16 v37, v65, s54, v37
    v_dot2_f32_bf16 v38, v69, s54, v38
    v_dot2_f32_bf16 v39, v73, s54, v39
    v_dot2_f32_bf16 v36, v62, s54, v36
    v_dot2_f32_bf16 v37, v66, s54, v37
    v_dot2_f32_bf16 v38, v70, s54, v38
    v_dot2_f32_bf16 v39, v74, s54, v39
    v_dot2_f32_bf16 v36, v63, s54, v36
    v_dot2_f32_bf16 v37, v67, s54, v37
    v_dot2_f32_bf16 v38, v71, s54, v38
    v_dot2_f32_bf16 v39, v75, s54, v39
    s_waitcnt vmcnt(12)
    ds_write_b128 v141, v[76:79] offset:0
    ds_write_b128 v141, v[80:83] offset:1152
    ds_write_b128 v141, v[84:87] offset:2304
    ds_write_b128 v141, v[88:91] offset:3456
    s_waitcnt lgkmcnt(0)
    ds_read_b64_tr_b16 v[76:77], v142 offset:0
    ds_read_b64_tr_b16 v[78:79], v142 offset:576
    ds_read_b64_tr_b16 v[80:81], v142 offset:32
    ds_read_b64_tr_b16 v[82:83], v142 offset:608
    ds_read_b64_tr_b16 v[84:85], v142 offset:64
    ds_read_b64_tr_b16 v[86:87], v142 offset:640
    ds_read_b64_tr_b16 v[88:89], v142 offset:96
    ds_read_b64_tr_b16 v[90:91], v142 offset:672
    s_waitcnt lgkmcnt(0)
    v_dot2_f32_bf16 v36, v76, s54, v36
    v_dot2_f32_bf16 v37, v80, s54, v37
    v_dot2_f32_bf16 v38, v84, s54, v38
    v_dot2_f32_bf16 v39, v88, s54, v39
    v_dot2_f32_bf16 v36, v77, s54, v36
    v_dot2_f32_bf16 v37, v81, s54, v37
    v_dot2_f32_bf16 v38, v85, s54, v38
    v_dot2_f32_bf16 v39, v89, s54, v39
    v_dot2_f32_bf16 v36, v78, s54, v36
    v_dot2_f32_bf16 v37, v82, s54, v37
    v_dot2_f32_bf16 v38, v86, s54, v38
    v_dot2_f32_bf16 v39, v90, s54, v39
    v_dot2_f32_bf16 v36, v79, s54, v36
    v_dot2_f32_bf16 v37, v83, s54, v37
    v_dot2_f32_bf16 v38, v87, s54, v38
    v_dot2_f32_bf16 v39, v91, s54, v39
    s_waitcnt vmcnt(8)
    ds_write_b128 v141, v[92:95] offset:0
    ds_write_b128 v141, v[96:99] offset:1152
    ds_write_b128 v141, v[100:103] offset:2304
    ds_write_b128 v141, v[104:107] offset:3456
    s_waitcnt lgkmcnt(0)
    ds_read_b64_tr_b16 v[92:93], v142 offset:0
    ds_read_b64_tr_b16 v[94:95], v142 offset:576
    ds_read_b64_tr_b16 v[96:97], v142 offset:32
    ds_read_b64_tr_b16 v[98:99], v142 offset:608
    ds_read_b64_tr_b16 v[100:101], v142 offset:64
    ds_read_b64_tr_b16 v[102:103], v142 offset:640
    ds_read_b64_tr_b16 v[104:105], v142 offset:96
    ds_read_b64_tr_b16 v[106:107], v142 offset:672
    s_waitcnt lgkmcnt(0)
    v_dot2_f32_bf16 v36, v92, s54, v36
    v_dot2_f32_bf16 v37, v96, s54, v37
    v_dot2_f32_bf16 v38, v100, s54, v38
    v_dot2_f32_bf16 v39, v104, s54, v39
    v_dot2_f32_bf16 v36, v93, s54, v36
    v_dot2_f32_bf16 v37, v97, s54, v37
    v_dot2_f32_bf16 v38, v101, s54, v38
    v_dot2_f32_bf16 v39, v105, s54, v39
    v_dot2_f32_bf16 v36, v94, s54, v36
    v_dot2_f32_bf16 v37, v98, s54, v37
    v_dot2_f32_bf16 v38, v102, s54, v38
    v_dot2_f32_bf16 v39, v106, s54, v39
    v_dot2_f32_bf16 v36, v95, s54, v36
    v_dot2_f32_bf16 v37, v99, s54, v37
    v_dot2_f32_bf16 v38, v103, s54, v38
    v_dot2_f32_bf16 v39, v107, s54, v39
    s_waitcnt vmcnt(4)
    ds_write_b128 v141, v[108:111] offset:0
    ds_write_b128 v141, v[112:115] offset:1152
    ds_write_b128 v141, v[116:119] offset:2304
    ds_write_b128 v141, v[120:123] offset:3456
    s_waitcnt lgkmcnt(0)
    ds_read_b64_tr_b16 v[108:109], v142 offset:0
    ds_read_b64_tr_b16 v[110:111], v142 offset:576
    ds_read_b64_tr_b16 v[112:113], v142 offset:32
    ds_read_b64_tr_b16 v[114:115], v142 offset:608
    ds_read_b64_tr_b16 v[116:117], v142 offset:64
    ds_read_b64_tr_b16 v[118:119], v142 offset:640
    ds_read_b64_tr_b16 v[120:121], v142 offset:96
    ds_read_b64_tr_b16 v[122:123], v142 offset:672
    s_waitcnt lgkmcnt(0)
    v_dot2_f32_bf16 v36, v108, s54, v36
    v_dot2_f32_bf16 v37, v112, s54, v37
    v_dot2_f32_bf16 v38, v116, s54, v38
    v_dot2_f32_bf16 v39, v120, s54, v39
    v_dot2_f32_bf16 v36, v109, s54, v36
    v_dot2_f32_bf16 v37, v113, s54, v37
    v_dot2_f32_bf16 v38, v117, s54, v38
    v_dot2_f32_bf16 v39, v121, s54, v39
    v_dot2_f32_bf16 v36, v110, s54, v36
    v_dot2_f32_bf16 v37, v114, s54, v37
    v_dot2_f32_bf16 v38, v118, s54, v38
    v_dot2_f32_bf16 v39, v122, s54, v39
    v_dot2_f32_bf16 v36, v111, s54, v36
    v_dot2_f32_bf16 v37, v115, s54, v37
    v_dot2_f32_bf16 v38, v119, s54, v38
    v_dot2_f32_bf16 v39, v123, s54, v39
    s_waitcnt vmcnt(0)
    ds_write_b128 v141, v[124:127] offset:0
    ds_write_b128 v141, v[128:131] offset:1152
    ds_write_b128 v141, v[132:135] offset:2304
    ds_write_b128 v141, v[136:139] offset:3456
    s_waitcnt lgkmcnt(0)
    ds_read_b64_tr_b16 v[124:125], v142 offset:0
    ds_read_b64_tr_b16 v[126:127], v142 offset:576
    ds_read_b64_tr_b16 v[128:129], v142 offset:32
    ds_read_b64_tr_b16 v[130:131], v142 offset:608
    ds_read_b64_tr_b16 v[132:133], v142 offset:64
    ds_read_b64_tr_b16 v[134:135], v142 offset:640
    ds_read_b64_tr_b16 v[136:137], v142 offset:96
    ds_read_b64_tr_b16 v[138:139], v142 offset:672
    s_waitcnt lgkmcnt(0)
    v_dot2_f32_bf16 v36, v124, s54, v36
    v_dot2_f32_bf16 v37, v128, s54, v37
    v_dot2_f32_bf16 v38, v132, s54, v38
    v_dot2_f32_bf16 v39, v136, s54, v39
    v_dot2_f32_bf16 v36, v125, s54, v36
    v_dot2_f32_bf16 v37, v129, s54, v37
    v_dot2_f32_bf16 v38, v133, s54, v38
    v_dot2_f32_bf16 v39, v137, s54, v39
    v_dot2_f32_bf16 v36, v126, s54, v36
    v_dot2_f32_bf16 v37, v130, s54, v37
    v_dot2_f32_bf16 v38, v134, s54, v38
    v_dot2_f32_bf16 v39, v138, s54, v39
    v_dot2_f32_bf16 v36, v127, s54, v36
    v_dot2_f32_bf16 v37, v131, s54, v37
    v_dot2_f32_bf16 v38, v135, s54, v38
    v_dot2_f32_bf16 v39, v139, s54, v39
    v_lshlrev_b32 v143, 4, v1
    buffer_store_dwordx4 v[44:47], v143, s[16:19], s44 offen sc1
    s_add_u32 s44, s44, s48
    buffer_store_dwordx4 v[48:51], v143, s[16:19], s45 offen sc1
    s_add_u32 s45, s45, s48
    buffer_store_dwordx4 v[52:55], v143, s[16:19], s46 offen sc1
    s_add_u32 s46, s46, s48
    buffer_store_dwordx4 v[56:59], v143, s[16:19], s47 offen sc1
    s_add_u32 s47, s47, s48
    buffer_store_dwordx4 v[60:63], v143, s[16:19], s44 offen sc1
    s_add_u32 s44, s44, s48
    buffer_store_dwordx4 v[64:67], v143, s[16:19], s45 offen sc1
    s_add_u32 s45, s45, s48
    buffer_store_dwordx4 v[68:71], v143, s[16:19], s46 offen sc1
    s_add_u32 s46, s46, s48
    buffer_store_dwordx4 v[72:75], v143, s[16:19], s47 offen sc1
    s_add_u32 s47, s47, s48
    buffer_store_dwordx4 v[76:79], v143, s[16:19], s44 offen sc1
    s_add_u32 s44, s44, s48
    buffer_store_dwordx4 v[80:83], v143, s[16:19], s45 offen sc1
    s_add_u32 s45, s45, s48
    buffer_store_dwordx4 v[84:87], v143, s[16:19], s46 offen sc1
    s_add_u32 s46, s46, s48
    buffer_store_dwordx4 v[88:91], v143, s[16:19], s47 offen sc1
    s_add_u32 s47, s47, s48
    buffer_store_dwordx4 v[92:95], v143, s[16:19], s44 offen sc1
    s_add_u32 s44, s44, s48
    buffer_store_dwordx4 v[96:99], v143, s[16:19], s45 offen sc1
    s_add_u32 s45, s45, s48
    buffer_store_dwordx4 v[100:103], v143, s[16:19], s46 offen sc1
    s_add_u32 s46, s46, s48
    buffer_store_dwordx4 v[104:107], v143, s[16:19], s47 offen sc1
    s_add_u32 s47, s47, s48
    buffer_store_dwordx4 v[108:111], v143, s[16:19], s44 offen sc1
    s_add_u32 s44, s44, s48
    buffer_store_dwordx4 v[112:115], v143, s[16:19], s45 offen sc1
    s_add_u32 s45, s45, s48
    buffer_store_dwordx4 v[116:119], v143, s[16:19], s46 offen sc1
    s_add_u32 s46, s46, s48
    buffer_store_dwordx4 v[120:123], v143, s[16:19], s47 offen sc1
    s_add_u32 s47, s47, s48
    buffer_store_dwordx4 v[124:127], v143, s[16:19], s44 offen sc1
    s_add_u32 s44, s44, s48
    buffer_store_dwordx4 v[128:131], v143, s[16:19], s45 offen sc1
    s_add_u32 s45, s45, s48
    buffer_store_dwordx4 v[132:135], v143, s[16:19], s46 offen sc1
    s_add_u32 s46, s46, s48
    buffer_store_dwordx4 v[136:139], v143, s[16:19], s47 offen sc1
    s_add_u32 s47, s47, s48
    s_cmp_eq_u32 s49, 0
    s_cbranch_scc1 Ljs_16
    v_mov_b32 v12, v36
    v_mov_b32 v13, v37
    v_mov_b32 v14, v38
    v_mov_b32 v15, v39
    v_permlane32_swap_b32 v36, v12
    v_permlane32_swap_b32 v37, v13
    v_permlane32_swap_b32 v38, v14
    v_permlane32_swap_b32 v39, v15
    v_add_f32 v36, v36, v12
    v_add_f32 v37, v37, v13
    v_add_f32 v38, v38, v14
    v_add_f32 v39, v39, v15
    v_mov_b32 v12, v36
    v_mov_b32 v13, v37
    v_mov_b32 v14, v38
    v_mov_b32 v15, v39
    v_permlane16_swap_b32 v36, v12
    v_permlane16_swap_b32 v37, v13
    v_permlane16_swap_b32 v38, v14
    v_permlane16_swap_b32 v39, v15
    v_add_f32 v36, v36, v12
    v_add_f32 v37, v37, v13
    v_add_f32 v38, v38, v14
    v_add_f32 v39, v39, v15
    v_lshlrev_b32 v12, 2, v1
    s_mov_b64 exec, s[64:65]
    buffer_store_dword v36, v12, s[16:19], s49 offen offset:0 sc1
    buffer_store_dword v37, v12, s[16:19], s49 offen offset:64 sc1
    buffer_store_dword v38, v12, s[16:19], s49 offen offset:128 sc1
    buffer_store_dword v39, v12, s[16:19], s49 offen offset:192 sc1
    s_mov_b64 exec, -1
Ljs_16:
    s_mov_b32 s73, 2
L_p0_j:
L_p0_jx:
    s_barrier
    s_cmp_eq_u32 s3, 8
    s_cbranch_scc0 L_p1_h8
    s_and_b32 s48, s29, 1
    s_lshl_b32 s48, s48, 2
    s_and_b32 s31, s30, 3
    s_add_u32 s48, s48, s31
    s_lshr_b32 s49, s29, 1
    s_lshl_b32 s49, s49, 3
    s_lshr_b32 s31, s30, 2
    s_add_u32 s49, s49, s31
    s_lshl_b32 s31, s3, 6
    v_add_u32 v12, s31, v1
    v_mul_u32_u24 v13, 911, v12
    v_lshrrev_b32 v13, 16, v13
    v_mul_u32_u24 v14, 72, v13
    v_sub_u32 v14, v12, v14
    v_xor_b32 v14, v14, v13
    v_mul_u32_u24 v13, 1152, v13
    v_lshl_add_u32 v4, v14, 4, v13
    s_mul_i32 s33, s49, 73728
    s_add_u32 s33, s33, 0x1960000
    s_lshl_b32 s31, s3, 10
    s_mov_b32 m0, s31
    s_add_u32 s31, s31, 9216
    buffer_load_dwordx4 v4, s[16:19], s33 offen sc1 lds
    s_add_u32 s33, s33, 9216
    s_mov_b32 m0, s31
    s_add_u32 s31, s31, 9216
    buffer_load_dwordx4 v4, s[16:19], s33 offen sc1 lds
    s_add_u32 s33, s33, 9216
    s_mov_b32 m0, s31
    s_add_u32 s31, s31, 9216
    buffer_load_dwordx4 v4, s[16:19], s33 offen sc1 lds
    s_add_u32 s33, s33, 9216
    s_mov_b32 m0, s31
    s_add_u32 s31, s31, 9216
    buffer_load_dwordx4 v4, s[16:19], s33 offen sc1 lds
    s_add_u32 s33, s33, 9216
    s_mov_b32 m0, s31
    s_add_u32 s31, s31, 9216
    buffer_load_dwordx4 v4, s[16:19], s33 offen sc1 lds
    s_add_u32 s33, s33, 9216
    s_mov_b32 m0, s31
    s_add_u32 s31, s31, 9216
    buffer_load_dwordx4 v4, s[16:19], s33 offen sc1 lds
    s_add_u32 s33, s33, 9216
    s_mov_b32 m0, s31
    s_add_u32 s31, s31, 9216
    buffer_load_dwordx4 v4, s[16:19], s33 offen sc1 lds
    s_add_u32 s33, s33, 9216
    s_mov_b32 m0, s31
    s_add_u32 s31, s31, 9216
    buffer_load_dwordx4 v4, s[16:19], s33 offen sc1 lds
    s_add_u32 s33, s33, 9216
L_p1_h8:
    s_barrier
    s_cmp_eq_u32 s3, 8
    s_cbranch_scc0 L_p1_h8b
    s_waitcnt vmcnt(0)
L_p1_h8b:
    s_barrier
    s_cmp_eq_u32 s3, 11
    s_cbranch_scc1 L_p1_h11
    s_cmp_eq_u32 s73, 1
    s_cbranch_scc0 L_p1_end
    v_lshrrev_b32 v12, 3, v1
    v_mul_u32_u24 v12, 144, v12
    v_and_b32 v13, 7, v1
    v_lshl_add_u32 v141, v13, 4, v12
    v_add_u32 v141, s51, v141
    v_lshrrev_b32 v12, 4, v1
    v_lshlrev_b32 v12, 3, v12
    v_bfe_u32 v13, v1, 2, 2
    v_add_u32 v12, v12, v13
    v_mul_u32_u24 v12, 144, v12
    v_and_b32 v13, 3, v1
    v_lshl_add_u32 v142, v13, 3, v12
    v_add_u32 v142, s51, v142
    v_mov_b32 v36, 0
    v_mov_b32 v37, 0
    v_mov_b32 v38, 0
    v_mov_b32 v39, 0
    s_mov_b32 s54, 0x3f803f80
    s_waitcnt vmcnt(20)
    ds_write_b128 v141, v[44:47] offset:0
    ds_write_b128 v141, v[48:51] offset:1152
    ds_write_b128 v141, v[52:55] offset:2304
    ds_write_b128 v141, v[56:59] offset:3456
    s_waitcnt lgkmcnt(0)
    ds_read_b64_tr_b16 v[44:45], v142 offset:0
    ds_read_b64_tr_b16 v[46:47], v142 offset:576
    ds_read_b64_tr_b16 v[48:49], v142 offset:32
    ds_read_b64_tr_b16 v[50:51], v142 offset:608
    ds_read_b64_tr_b16 v[52:53], v142 offset:64
    ds_read_b64_tr_b16 v[54:55], v142 offset:640
    ds_read_b64_tr_b16 v[56:57], v142 offset:96
    ds_read_b64_tr_b16 v[58:59], v142 offset:672
    s_waitcnt lgkmcnt(0)
    v_dot2_f32_bf16 v36, v44, s54, v36
    v_dot2_f32_bf16 v37, v48, s54, v37
    v_dot2_f32_bf16 v38, v52, s54, v38
    v_dot2_f32_bf16 v39, v56, s54, v39
    v_dot2_f32_bf16 v36, v45, s54, v36
    v_dot2_f32_bf16 v37, v49, s54, v37
    v_dot2_f32_bf16 v38, v53, s54, v38
    v_dot2_f32_bf16 v39, v57, s54, v39
    v_dot2_f32_bf16 v36, v46, s54, v36
    v_dot2_f32_bf16 v37, v50, s54, v37
    v_dot2_f32_bf16 v38, v54, s54, v38
    v_dot2_f32_bf16 v39, v58, s54, v39
    v_dot2_f32_bf16 v36, v47, s54, v36
    v_dot2_f32_bf16 v37, v51, s54, v37
    v_dot2_f32_bf16 v38, v55, s54, v38
    v_dot2_f32_bf16 v39, v59, s54, v39
    s_waitcnt vmcnt(16)
    ds_write_b128 v141, v[60:63] offset:0
    ds_write_b128 v141, v[64:67] offset:1152
    ds_write_b128 v141, v[68:71] offset:2304
    ds_write_b128 v141, v[72:75] offset:3456
    s_waitcnt lgkmcnt(0)
    ds_read_b64_tr_b16 v[60:61], v142 offset:0
    ds_read_b64_tr_b16 v[62:63], v142 offset:576
    ds_read_b64_tr_b16 v[64:65], v142 offset:32
    ds_read_b64_tr_b16 v[66:67], v142 offset:608
    ds_read_b64_tr_b16 v[68:69], v142 offset:64
    ds_read_b64_tr_b16 v[70:71], v142 offset:640
    ds_read_b64_tr_b16 v[72:73], v142 offset:96
    ds_read_b64_tr_b16 v[74:75], v142 offset:672
    s_waitcnt lgkmcnt(0)
    v_dot2_f32_bf16 v36, v60, s54, v36
    v_dot2_f32_bf16 v37, v64, s54, v37
    v_dot2_f32_bf16 v38, v68, s54, v38
    v_dot2_f32_bf16 v39, v72, s54, v39
    v_dot2_f32_bf16 v36, v61, s54, v36
    v_dot2_f32_bf16 v37, v65, s54, v37
    v_dot2_f32_bf16 v38, v69, s54, v38
    v_dot2_f32_bf16 v39, v73, s54, v39
    v_dot2_f32_bf16 v36, v62, s54, v36
    v_dot2_f32_bf16 v37, v66, s54, v37
    v_dot2_f32_bf16 v38, v70, s54, v38
    v_dot2_f32_bf16 v39, v74, s54, v39
    v_dot2_f32_bf16 v36, v63, s54, v36
    v_dot2_f32_bf16 v37, v67, s54, v37
    v_dot2_f32_bf16 v38, v71, s54, v38
    v_dot2_f32_bf16 v39, v75, s54, v39
    s_waitcnt vmcnt(12)
    ds_write_b128 v141, v[76:79] offset:0
    ds_write_b128 v141, v[80:83] offset:1152
    ds_write_b128 v141, v[84:87] offset:2304
    ds_write_b128 v141, v[88:91] offset:3456
    s_waitcnt lgkmcnt(0)
    ds_read_b64_tr_b16 v[76:77], v142 offset:0
    ds_read_b64_tr_b16 v[78:79], v142 offset:576
    ds_read_b64_tr_b16 v[80:81], v142 offset:32
    ds_read_b64_tr_b16 v[82:83], v142 offset:608
    ds_read_b64_tr_b16 v[84:85], v142 offset:64
    ds_read_b64_tr_b16 v[86:87], v142 offset:640
    ds_read_b64_tr_b16 v[88:89], v142 offset:96
    ds_read_b64_tr_b16 v[90:91], v142 offset:672
    s_waitcnt lgkmcnt(0)
    v_dot2_f32_bf16 v36, v76, s54, v36
    v_dot2_f32_bf16 v37, v80, s54, v37
    v_dot2_f32_bf16 v38, v84, s54, v38
    v_dot2_f32_bf16 v39, v88, s54, v39
    v_dot2_f32_bf16 v36, v77, s54, v36
    v_dot2_f32_bf16 v37, v81, s54, v37
    v_dot2_f32_bf16 v38, v85, s54, v38
    v_dot2_f32_bf16 v39, v89, s54, v39
    v_dot2_f32_bf16 v36, v78, s54, v36
    v_dot2_f32_bf16 v37, v82, s54, v37
    v_dot2_f32_bf16 v38, v86, s54, v38
    v_dot2_f32_bf16 v39, v90, s54, v39
    v_dot2_f32_bf16 v36, v79, s54, v36
    v_dot2_f32_bf16 v37, v83, s54, v37
    v_dot2_f32_bf16 v38, v87, s54, v38
    v_dot2_f32_bf16 v39, v91, s54, v39
    s_waitcnt vmcnt(8)
    ds_write_b128 v141, v[92:95] offset:0
    ds_write_b128 v141, v[96:99] offset:1152
    ds_write_b128 v141, v[100:103] offset:2304
    ds_write_b128 v141, v[104:107] offset:3456
    s_waitcnt lgkmcnt(0)
    ds_read_b64_tr_b16 v[92:93], v142 offset:0
    ds_read_b64_tr_b16 v[94:95], v142 offset:576
    ds_read_b64_tr_b16 v[96:97], v142 offset:32
    ds_read_b64_tr_b16 v[98:99], v142 offset:608
    ds_read_b64_tr_b16 v[100:101], v142 offset:64
    ds_read_b64_tr_b16 v[102:103], v142 offset:640
    ds_read_b64_tr_b16 v[104:105], v142 offset:96
    ds_read_b64_tr_b16 v[106:107], v142 offset:672
    s_waitcnt lgkmcnt(0)
    v_dot2_f32_bf16 v36, v92, s54, v36
    v_dot2_f32_bf16 v37, v96, s54, v37
    v_dot2_f32_bf16 v38, v100, s54, v38
    v_dot2_f32_bf16 v39, v104, s54, v39
    v_dot2_f32_bf16 v36, v93, s54, v36
    v_dot2_f32_bf16 v37, v97, s54, v37
    v_dot2_f32_bf16 v38, v101, s54, v38
    v_dot2_f32_bf16 v39, v105, s54, v39
    v_dot2_f32_bf16 v36, v94, s54, v36
    v_dot2_f32_bf16 v37, v98, s54, v37
    v_dot2_f32_bf16 v38, v102, s54, v38
    v_dot2_f32_bf16 v39, v106, s54, v39
    v_dot2_f32_bf16 v36, v95, s54, v36
    v_dot2_f32_bf16 v37, v99, s54, v37
    v_dot2_f32_bf16 v38, v103, s54, v38
    v_dot2_f32_bf16 v39, v107, s54, v39
    s_waitcnt vmcnt(4)
    ds_write_b128 v141, v[108:111] offset:0
    ds_write_b128 v141, v[112:115] offset:1152
    ds_write_b128 v141, v[116:119] offset:2304
    ds_write_b128 v141, v[120:123] offset:3456
    s_waitcnt lgkmcnt(0)
    ds_read_b64_tr_b16 v[108:109], v142 offset:0
    ds_read_b64_tr_b16 v[110:111], v142 offset:576
    ds_read_b64_tr_b16 v[112:113], v142 offset:32
    ds_read_b64_tr_b16 v[114:115], v142 offset:608
    ds_read_b64_tr_b16 v[116:117], v142 offset:64
    ds_read_b64_tr_b16 v[118:119], v142 offset:640
    ds_read_b64_tr_b16 v[120:121], v142 offset:96
    ds_read_b64_tr_b16 v[122:123], v142 offset:672
    s_waitcnt lgkmcnt(0)
    v_dot2_f32_bf16 v36, v108, s54, v36
    v_dot2_f32_bf16 v37, v112, s54, v37
    v_dot2_f32_bf16 v38, v116, s54, v38
    v_dot2_f32_bf16 v39, v120, s54, v39
    v_dot2_f32_bf16 v36, v109, s54, v36
    v_dot2_f32_bf16 v37, v113, s54, v37
    v_dot2_f32_bf16 v38, v117, s54, v38
    v_dot2_f32_bf16 v39, v121, s54, v39
    v_dot2_f32_bf16 v36, v110, s54, v36
    v_dot2_f32_bf16 v37, v114, s54, v37
    v_dot2_f32_bf16 v38, v118, s54, v38
    v_dot2_f32_bf16 v39, v122, s54, v39
    v_dot2_f32_bf16 v36, v111, s54, v36
    v_dot2_f32_bf16 v37, v115, s54, v37
    v_dot2_f32_bf16 v38, v119, s54, v38
    v_dot2_f32_bf16 v39, v123, s54, v39
    s_waitcnt vmcnt(0)
    ds_write_b128 v141, v[124:127] offset:0
    ds_write_b128 v141, v[128:131] offset:1152
    ds_write_b128 v141, v[132:135] offset:2304
    ds_write_b128 v141, v[136:139] offset:3456
    s_waitcnt lgkmcnt(0)
    ds_read_b64_tr_b16 v[124:125], v142 offset:0
    ds_read_b64_tr_b16 v[126:127], v142 offset:576
    ds_read_b64_tr_b16 v[128:129], v142 offset:32
    ds_read_b64_tr_b16 v[130:131], v142 offset:608
    ds_read_b64_tr_b16 v[132:133], v142 offset:64
    ds_read_b64_tr_b16 v[134:135], v142 offset:640
    ds_read_b64_tr_b16 v[136:137], v142 offset:96
    ds_read_b64_tr_b16 v[138:139], v142 offset:672
    s_waitcnt lgkmcnt(0)
    v_dot2_f32_bf16 v36, v124, s54, v36
    v_dot2_f32_bf16 v37, v128, s54, v37
    v_dot2_f32_bf16 v38, v132, s54, v38
    v_dot2_f32_bf16 v39, v136, s54, v39
    v_dot2_f32_bf16 v36, v125, s54, v36
    v_dot2_f32_bf16 v37, v129, s54, v37
    v_dot2_f32_bf16 v38, v133, s54, v38
    v_dot2_f32_bf16 v39, v137, s54, v39
    v_dot2_f32_bf16 v36, v126, s54, v36
    v_dot2_f32_bf16 v37, v130, s54, v37
    v_dot2_f32_bf16 v38, v134, s54, v38
    v_dot2_f32_bf16 v39, v138, s54, v39
    v_dot2_f32_bf16 v36, v127, s54, v36
    v_dot2_f32_bf16 v37, v131, s54, v37
    v_dot2_f32_bf16 v38, v135, s54, v38
    v_dot2_f32_bf16 v39, v139, s54, v39
    s_branch L_p1_end
L_p1_h11:
    s_cmp_eq_u32 s73, 2
    s_cbranch_scc0 L_p1_h11b
    s_waitcnt vmcnt(0)
    s_and_b32 s48, s29, 1
    s_lshl_b32 s48, s48, 2
    s_and_b32 s31, s30, 3
    s_add_u32 s48, s48, s31
    s_lshr_b32 s49, s29, 1
    s_lshl_b32 s49, s49, 3
    s_lshr_b32 s31, s30, 2
    s_add_u32 s49, s49, s31
    s_lshl_b32 s31, s48, 2
    s_lshr_b32 s33, 0xcc88cc89, s31
    s_and_b32 s33, s33, 15
    s_lshl_b32 s31, s48, 7
    s_lshl_b32 s32, s48, 10
    s_mov_b64 exec, 1
    v_mov_b32 v12, 1
    v_mov_b32 v13, 0x3c800
    buffer_atomic_add v12, v13, s[16:19], s31 offen sc0 sc1
    s_waitcnt vmcnt(0)
    v_readfirstlane_b32 s72, v12
    s_mov_b64 exec, -1
    s_add_u32 s72, s72, 1
    s_cmp_eq_u32 s72, s33
    s_cbranch_scc0 Larr_17
    s_mov_b64 exec, 0xff
    v_lshlrev_b32 v13, 7, v1
    v_add_u32 v13, 0x70000, v13
    v_mov_b32 v12, s28
    buffer_store_dword v12, v13, s[16:19], s32 offen sc1
    s_mov_b64 exec, -1
Larr_17:
L_p1_h11b:
    v_lshlrev_b32 v12, 10, v1
    s_lshl_b32 s31, s29, 7
    s_add_u32 s31, s31, 0x70000
    v_add_u32 v12, s31, v12
    s_mov_b32 exec_lo, 0xff
    s_mov_b32 exec_hi, 0x0
    s_mov_b32 s72, 0x40000
Lpoll_18:
    buffer_load_dword v13, v12, s[16:19], 0 offen sc1
    s_waitcnt vmcnt(0)
    v_cmp_ne_u32 vcc, s28, v13
    s_cbranch_vccz Lpolld_19
    s_sub_u32 s72, s72, 1
    s_cbranch_scc1 Lpolld_19
    s_sleep 8
    s_branch Lpoll_18
Lpolld_19:
    s_mov_b64 exec, -1
L_p1_end:
    s_waitcnt vmcnt(0) lgkmcnt(0)
    s_barrier
    s_cmp_eq_u32 s3, 0
    s_cbranch_scc0 L_p1_nf
    s_lshl_b32 s31, s48, 7
    s_lshl_b32 s32, s48, 10
    s_mov_b64 exec, 1
    v_mov_b32 v12, 1
    v_mov_b32 v13, 0x3c000
    buffer_atomic_add v12, v13, s[16:19], s31 offen sc0 sc1
    s_waitcnt vmcnt(0)
    v_readfirstlane_b32 s72, v12
    s_mov_b64 exec, -1
    s_cmp_eq_u32 s72, 31
    s_cbranch_scc0 Larr_20
    s_mov_b64 exec, 0xff
    v_lshlrev_b32 v13, 7, v1
    v_add_u32 v13, 0x3d000, v13
    v_mov_b32 v12, s28
    buffer_store_dword v12, v13, s[16:19], s32 offen sc1
    s_mov_b64 exec, -1
Larr_20:
L_p1_nf:
    s_cmp_lt_u32 s3, 9
    s_cbranch_scc1 L_p1_ns
    s_cmp_eq_u32 s3, 11
    s_cbranch_scc1 L_p1_ns
    s_cmp_eq_u32 s73, 1
    s_cbranch_scc0 L_p1_ns
    v_lshlrev_b32 v143, 4, v1
    buffer_store_dwordx4 v[44:47], v143, s[16:19], s44 offen sc1
    s_add_u32 s44, s44, s48
    buffer_store_dwordx4 v[48:51], v143, s[16:19], s45 offen sc1
    s_add_u32 s45, s45, s48
    buffer_store_dwordx4 v[52:55], v143, s[16:19], s46 offen sc1
    s_add_u32 s46, s46, s48
    buffer_store_dwordx4 v[56:59], v143, s[16:19], s47 offen sc1
    s_add_u32 s47, s47, s48
    buffer_store_dwordx4 v[60:63], v143, s[16:19], s44 offen sc1
    s_add_u32 s44, s44, s48
    buffer_store_dwordx4 v[64:67], v143, s[16:19], s45 offen sc1
    s_add_u32 s45, s45, s48
    buffer_store_dwordx4 v[68:71], v143, s[16:19], s46 offen sc1
    s_add_u32 s46, s46, s48
    buffer_store_dwordx4 v[72:75], v143, s[16:19], s47 offen sc1
    s_add_u32 s47, s47, s48
    buffer_store_dwordx4 v[76:79], v143, s[16:19], s44 offen sc1
    s_add_u32 s44, s44, s48
    buffer_store_dwordx4 v[80:83], v143, s[16:19], s45 offen sc1
    s_add_u32 s45, s45, s48
    buffer_store_dwordx4 v[84:87], v143, s[16:19], s46 offen sc1
    s_add_u32 s46, s46, s48
    buffer_store_dwordx4 v[88:91], v143, s[16:19], s47 offen sc1
    s_add_u32 s47, s47, s48
    buffer_store_dwordx4 v[92:95], v143, s[16:19], s44 offen sc1
    s_add_u32 s44, s44, s48
    buffer_store_dwordx4 v[96:99], v143, s[16:19], s45 offen sc1
    s_add_u32 s45, s45, s48
    buffer_store_dwordx4 v[100:103], v143, s[16:19], s46 offen sc1
    s_add_u32 s46, s46, s48
    buffer_store_dwordx4 v[104:107], v143, s[16:19], s47 offen sc1
    s_add_u32 s47, s47, s48
    buffer_store_dwordx4 v[108:111], v143, s[16:19], s44 offen sc1
    s_add_u32 s44, s44, s48
    buffer_store_dwordx4 v[112:115], v143, s[16:19], s45 offen sc1
    s_add_u32 s45, s45, s48
    buffer_store_dwordx4 v[116:119], v143, s[16:19], s46 offen sc1
    s_add_u32 s46, s46, s48
    buffer_store_dwordx4 v[120:123], v143, s[16:19], s47 offen sc1
    s_add_u32 s47, s47, s48
    buffer_store_dwordx4 v[124:127], v143, s[16:19], s44 offen sc1
    s_add_u32 s44, s44, s48
    buffer_store_dwordx4 v[128:131], v143, s[16:19], s45 offen sc1
    s_add_u32 s45, s45, s48
    buffer_store_dwordx4 v[132:135], v143, s[16:19], s46 offen sc1
    s_add_u32 s46, s46, s48
    buffer_store_dwordx4 v[136:139], v143, s[16:19], s47 offen sc1
    s_add_u32 s47, s47, s48
    s_cmp_eq_u32 s49, 0
    s_cbranch_scc1 Ljs_21
    v_mov_b32 v12, v36
    v_mov_b32 v13, v37
    v_mov_b32 v14, v38
    v_mov_b32 v15, v39
    v_permlane32_swap_b32 v36, v12
    v_permlane32_swap_b32 v37, v13
    v_permlane32_swap_b32 v38, v14
    v_permlane32_swap_b32 v39, v15
    v_add_f32 v36, v36, v12
    v_add_f32 v37, v37, v13
    v_add_f32 v38, v38, v14
    v_add_f32 v39, v39, v15
    v_mov_b32 v12, v36
    v_mov_b32 v13, v37
    v_mov_b32 v14, v38
    v_mov_b32 v15, v39
    v_permlane16_swap_b32 v36, v12
    v_permlane16_swap_b32 v37, v13
    v_permlane16_swap_b32 v38, v14
    v_permlane16_swap_b32 v39, v15
    v_add_f32 v36, v36, v12
    v_add_f32 v37, v37, v13
    v_add_f32 v38, v38, v14
    v_add_f32 v39, v39, v15
    v_lshlrev_b32 v12, 2, v1
    s_mov_b64 exec, s[64:65]
    buffer_store_dword v36, v12, s[16:19], s49 offen offset:0 sc1
    buffer_store_dword v37, v12, s[16:19], s49 offen offset:64 sc1
    buffer_store_dword v38, v12, s[16:19], s49 offen offset:128 sc1
    buffer_store_dword v39, v12, s[16:19], s49 offen offset:192 sc1
    s_mov_b64 exec, -1
Ljs_21:
L_p1_ns:
    s_lshl_b32 s61, s29, 3
    s_lshr_b32 s31, s30, 2
    s_add_u32 s61, s61, s31
    s_and_b32 s62, s30, 3
    s_lshl_b32 s63, s61, 2
    s_add_u32 s63, s63, s62
    v_lshlrev_b32 v3, 4, v1
    v_and_b32 v12, 15, v1
    v_lshrrev_b32 v13, 4, v1
    v_mul_u32_u24 v5, 288, v12
    v_lshl_add_u32 v5, v13, 3, v5
    s_lshl_b32 s31, s3, 5
    v_add_u32 v5, s31, v5
    v_lshlrev_b32 v6, 3, v12
    s_lshl_b32 s31, s3, 8
    s_add_u32 s31, s31, 55296
    v_add_u32 v6, s31, v6
    s_lshl_b32 s31, s3, 6
    v_add_u32 v12, s31, v1
    v_mul_u32_u24 v13, 911, v12
    v_lshrrev_b32 v13, 16, v13
    v_mul_u32_u24 v14, 72, v13
    v_sub_u32 v14, v12, v14
    v_xor_b32 v14, v14, v13
    v_mul_u32_u24 v15, 57, v14
    v_lshrrev_b32 v15, 10, v15
    v_mul_u32_u24 v16, 18, v15
    v_sub_u32 v16, v14, v16
    v_mul_u32_u24 v13, 288, v13
    v_lshl_add_u32 v13, v16, 4, v13
    s_mov_b32 s31, 589824
    v_mul_lo_u32 v15, v15, s31
    v_add_u32 v4, v13, v15
    s_cmp_ge_u32 s3, 9
    s_cbranch_scc1 L_p2_nw
    s_mul_i32 s31, s62, 9
    s_add_u32 s31, s31, s3
    s_mul_i32 s31, s31, 18432
    s_add_u32 s31, s31, 0xa00000
    buffer_load_dwordx4 v[96:99], v3, s[16:19], s31 offen offset:0 sc1
    buffer_load_dwordx4 v[100:103], v3, s[16:19], s31 offen offset:1024 sc1
    buffer_load_dwordx4 v[104:107], v3, s[16:19], s31 offen offset:2048 sc1
    buffer_load_dwordx4 v[108:111], v3, s[16:19], s31 offen offset:3072 sc1
    s_add_u32 s31, s31, 4096
    buffer_load_dwordx4 v[112:115], v3, s[16:19], s31 offen offset:0 sc1
    buffer_load_dwordx4 v[116:119], v3, s[16:19], s31 offen offset:1024 sc1
    buffer_load_dwordx4 v[120:123], v3, s[16:19], s31 offen offset:2048 sc1
    buffer_load_dwordx4 v[124:127], v3, s[16:19], s31 offen offset:3072 sc1
    s_add_u32 s31, s31, 4096
    buffer_load_dwordx4 v[128:131], v3, s[16:19], s31 offen offset:0 sc1
    buffer_load_dwordx4 v[132:135], v3, s[16:19], s31 offen offset:1024 sc1
    buffer_load_dwordx4 v[136:139], v3, s[16:19], s31 offen offset:2048 sc1
    buffer_load_dwordx4 v[140:143], v3, s[16:19], s31 offen offset:3072 sc1
    s_add_u32 s31, s31, 4096
    buffer_load_dwordx4 v[144:147], v3, s[16:19], s31 offen offset:0 sc1
    buffer_load_dwordx4 v[148:151], v3, s[16:19], s31 offen offset:1024 sc1
    buffer_load_dwordx4 v[152:155], v3, s[16:19], s31 offen offset:2048 sc1
    buffer_load_dwordx4 v[156:159], v3, s[16:19], s31 offen offset:3072 sc1
    s_add_u32 s31, s31, 4096
    buffer_load_dwordx4 v[160:163], v3, s[16:19], s31 offen offset:0 sc1
    buffer_load_dwordx4 v[164:167], v3, s[16:19], s31 offen offset:1024 sc1
L_p2_nw:
    s_cmp_eq_u32 s3, 11
    s_cbranch_scc0 L_p2_np
    v_lshlrev_b32 v12, 10, v1
    s_lshl_b32 s31, s29, 7
    s_add_u32 s31, s31, 0x3d000
    v_add_u32 v12, s31, v12
    s_mov_b32 exec_lo, 0xff
    s_mov_b32 exec_hi, 0x0
    s_mov_b32 s72, 0x40000
Lpoll_22:
    buffer_load_dword v13, v12, s[16:19], 0 offen sc1
    s_waitcnt vmcnt(0)
    v_cmp_ne_u32 vcc, s28, v13
    s_cbranch_vccz Lpolld_23
    s_sub_u32 s72, s72, 1
    s_cbranch_scc1 Lpolld_23
    s_sleep 2
    s_branch Lpoll_22
Lpolld_23:
    s_mov_b64 exec, -1
    s_cmp_eq_u32 s2, 0
    s_cbranch_scc0 L_p2_ne
    s_mov_b32 s31, 0
    s_mov_b64 exec, 1
    v_mov_b32 v12, s28
    v_mov_b32 v13, 0x0
    buffer_store_dword v12, v13, s[16:19], s31 offen sc1
    s_mov_b64 exec, -1
L_p2_ne:
    s_waitcnt lgkmcnt(0)
L_p2_np:
    s_barrier
    s_cmp_lt_u32 s3, 9
    s_cbranch_scc1 L_p2_na
    s_cmp_eq_u32 s3, 11
    s_cbranch_scc1 L_p2_na
    s_cmp_eq_u32 s73, 1
    s_cbranch_scc0 L_p2_na
    s_waitcnt vmcnt(0)
    s_lshl_b32 s31, s58, 7
    s_mov_b64 exec, 1
    v_mov_b32 v12, 1
    v_mov_b32 v13, 0x3c400
    buffer_atomic_add v12, v13, s[16:19], s31 offen sc0 sc1
    s_waitcnt vmcnt(0)
    v_readfirstlane_b32 s72, v12
    s_mov_b64 exec, -1
    s_cmp_eq_u32 s72, 26
    s_cbranch_scc0 Larr_24
    s_mov_b64 exec, 0x1
    v_lshlrev_b32 v13, 7, v1
    v_add_u32 v13, 0x3f000, v13
    v_mov_b32 v12, s28
    buffer_store_dword v12, v13, s[16:19], s31 offen sc1
    s_mov_b64 exec, -1
Larr_24:
L_p2_na:
    s_lshl_b32 s31, s3, 12
    s_add_u32 s32, s31, 0x30000
    s_add_u32 s31, s31, 61440
    s_add_u32 m0, s31, 0
    s_nop 0
    buffer_load_dwordx4 v3, s[16:19], s32 offen sc1 lds
    s_add_u32 s32, s32, 1024
    s_add_u32 m0, s31, 1024
    s_nop 0
    buffer_load_dwordx4 v3, s[16:19], s32 offen sc1 lds
    s_add_u32 s32, s32, 1024
    s_add_u32 m0, s31, 2048
    s_nop 0
    buffer_load_dwordx4 v3, s[16:19], s32 offen sc1 lds
    s_add_u32 s32, s32, 1024
    s_add_u32 m0, s31, 3072
    s_nop 0
    buffer_load_dwordx4 v3, s[16:19], s32 offen sc1 lds
    s_add_u32 s32, s32, 1024
    s_mul_i32 s33, s61, 1152
    s_add_u32 s33, s33, 0x100000
    s_mul_i32 s31, s3, 192
    s_mul_i32 s34, s3, 3072
    s_add_u32 s34, s34, 110592
    s_mov_b32 s35, 73728
    v_add_u32 v12, s31, v1
    v_mul_u32_u24 v13, 58255, v12
    v_lshrrev_b32 v13, 22, v13
    v_mul_u32_u24 v14, 72, v13
    v_sub_u32 v14, v12, v14
    v_mul_lo_u32 v13, v13, s35
    v_lshl_add_u32 v13, v14, 4, v13
    s_add_u32 m0, s34, 0
    s_nop 0
    buffer_load_dwordx4 v13, s[16:19], s33 offen sc1 lds
    v_add_u32 v12, s31, v1
    v_add_u32 v12, 64, v12
    v_mul_u32_u24 v13, 58255, v12
    v_lshrrev_b32 v13, 22, v13
    v_mul_u32_u24 v14, 72, v13
    v_sub_u32 v14, v12, v14
    v_mul_lo_u32 v13, v13, s35
    v_lshl_add_u32 v13, v14, 4, v13
    s_add_u32 m0, s34, 1024
    s_nop 0
    buffer_load_dwordx4 v13, s[16:19], s33 offen sc1 lds
    v_add_u32 v12, s31, v1
    v_add_u32 v12, 128, v12
    v_mul_u32_u24 v13, 58255, v12
    v_lshrrev_b32 v13, 22, v13
    v_mul_u32_u24 v14, 72, v13
    v_sub_u32 v14, v12, v14
    v_mul_lo_u32 v13, v13, s35
    v_lshl_add_u32 v13, v14, 4, v13
    s_add_u32 m0, s34, 2048
    s_nop 0
    buffer_load_dwordx4 v13, s[16:19], s33 offen sc1 lds
    s_waitcnt vmcnt(0)
    s_barrier
    s_cmp_eq_u32 s3, 11
    s_cbranch_scc1 L_p2_w11
    v_and_b32 v2, 15, v1
    v_lshrrev_b32 v7, 4, v1
    v_cmp_eq_u32 vcc, 3, v7
    s_nop 1
    v_cndmask_b32 v10, 0, -1, vcc
    v_mul_u32_u24 v8, 1152, v2
    v_and_b32 v9, 7, v2
    v_lshlrev_b32 v11, 6, v2
    v_lshl_add_u32 v11, v7, 4, v11
    v_add_u32 v11, 61440, v11
    v_and_b32 v16, 3, v2
    v_cmp_eq_u32 vcc, 2, v16
    s_nop 1
    v_cndmask_b32 v16, 19, 18, vcc
    v_add_u32 v17, 16, v2
    v_cmp_gt_u32 vcc, 2, v2
    s_nop 1
    v_cndmask_b32 v16, v16, v17, vcc
    v_lshlrev_b32 v12, 6, v16
    v_lshl_add_u32 v12, v7, 4, v12
    v_add_u32 v12, 61440, v12
    v_cmp_eq_u32 vcc, 3, v7
    s_nop 1
    v_cndmask_b32 v17, 20, v2, vcc
    v_lshlrev_b32 v13, 2, v17
    v_add_u32 v13, 62720, v13
    v_cndmask_b32 v17, 20, v16, vcc
    v_cmp_eq_u32 vcc, 19, v17
    s_nop 1
    v_cndmask_b32 v17, v17, 20, vcc
    v_lshlrev_b32 v14, 2, v17
    v_add_u32 v14, 62720, v14
    v_mul_u32_u24 v15, 36, v2
    v_lshl_add_u32 v15, v7, 3, v15
    v_add_u32 v15, 110592, v15
    s_mov_b32 s33, 0x358637bd
    s_mul_i32 s32, s3, 3
    s_add_u32 s32, s32, 0
    s_min_u32 s32, s32, 31
    s_mul_i32 s34, s32, 1536
    s_mul_i32 s35, s32, 1152
    v_add_u32 v16, s34, v11
    ds_read_b128 v[20:23], v16
    v_add_u32 v17, s34, v12
    ds_read_b128 v[24:27], v17
    v_add_u32 v18, s34, v13
    ds_read2_b32 v[28:29], v18 offset0:0 offset1:32
    v_add_u32 v19, s34, v14
    ds_read2_b32 v[30:31], v19 offset0:0 offset1:32
    v_add_u32 v16, s35, v15
    ds_read2_b32 v[32:33], v16 offset0:0 offset1:1
    ds_read_b32 v34, v16 offset:8
    ds_read2_b32 v[36:37], v16 offset0:144 offset1:145
    ds_read_b32 v38, v16 offset:584
    s_mul_i32 s32, s3, 3
    s_add_u32 s32, s32, 1
    s_min_u32 s32, s32, 31
    s_mul_i32 s34, s32, 1536
    s_mul_i32 s35, s32, 1152
    v_add_u32 v16, s34, v11
    ds_read_b128 v[40:43], v16
    v_add_u32 v17, s34, v12
    ds_read_b128 v[44:47], v17
    v_add_u32 v18, s34, v13
    ds_read2_b32 v[48:49], v18 offset0:0 offset1:32
    v_add_u32 v19, s34, v14
    ds_read2_b32 v[50:51], v19 offset0:0 offset1:32
    v_add_u32 v16, s35, v15
    ds_read2_b32 v[52:53], v16 offset0:0 offset1:1
    ds_read_b32 v54, v16 offset:8
    ds_read2_b32 v[56:57], v16 offset0:144 offset1:145
    ds_read_b32 v58, v16 offset:584
    s_mul_i32 s32, s3, 3
    s_add_u32 s32, s32, 2
    s_min_u32 s32, s32, 31
    s_mul_i32 s34, s32, 1536
    s_mul_i32 s35, s32, 1152
    v_add_u32 v16, s34, v11
    ds_read_b128 v[60:63], v16
    v_add_u32 v17, s34, v12
    ds_read_b128 v[64:67], v17
    v_add_u32 v18, s34, v13
    ds_read2_b32 v[68:69], v18 offset0:0 offset1:32
    v_add_u32 v19, s34, v14
    ds_read2_b32 v[70:71], v19 offset0:0 offset1:32
    v_add_u32 v16, s35, v15
    ds_read2_b32 v[72:73], v16 offset0:0 offset1:1
    ds_read_b32 v74, v16 offset:8
    ds_read2_b32 v[76:77], v16 offset0:144 offset1:145
    ds_read_b32 v78, v16 offset:584
    s_waitcnt lgkmcnt(15)
    v_cvt_pk_bf16_f32 v20, v20, v21
    v_cvt_pk_bf16_f32 v21, v22, v23
    v_cvt_pk_bf16_f32 v24, v24, v25
    v_cvt_pk_bf16_f32 v25, v26, v27
    v_cvt_pk_bf16_f32 v28, v28, v29
    v_mov_b32 v29, 0
    v_cvt_pk_bf16_f32 v30, v30, v31
    v_mov_b32 v31, 0
    v_and_b32 v34, v10, v34
    v_mov_b32 v35, 0
    v_and_b32 v38, v10, v38
    v_mov_b32 v39, 0
    v_mfma_f32_16x16x16_bf16 v[80:83], v[20:21], v[32:33], 0
    v_mfma_f32_16x16x16_bf16 v[84:87], v[24:25], v[32:33], 0
    v_mfma_f32_16x16x16_bf16 v[88:91], v[20:21], v[36:37], 0
    v_mfma_f32_16x16x16_bf16 v[92:95], v[24:25], v[36:37], 0
    v_mfma_f32_16x16x16_bf16 v[80:83], v[28:29], v[34:35], v[80:83]
    v_mfma_f32_16x16x16_bf16 v[84:87], v[30:31], v[34:35], v[84:87]
    v_mfma_f32_16x16x16_bf16 v[88:91], v[28:29], v[38:39], v[88:91]
    v_mfma_f32_16x16x16_bf16 v[92:95], v[30:31], v[38:39], v[92:95]
    s_mul_i32 s32, s3, 3
    s_add_u32 s32, s32, 0
    s_min_u32 s32, s32, 31
    s_and_b32 s34, s32, 1
    s_mul_i32 s35, s32, 36
    s_lshl_b32 s36, s34, 2
    s_add_u32 s36, s36, s35
    s_xor_b32 s37, s34, 1
    s_lshl_b32 s37, s37, 5
    s_add_u32 s37, s37, s35
    v_lshl_add_u32 v16, v7, 3, s36
    v_lshrrev_b32 v17, 4, v16
    v_xor_b32 v17, v17, v9
    v_and_b32 v16, 15, v16
    v_lshl_add_u32 v16, v17, 4, v16
    v_add_u32 v16, v16, v8
    s_lshr_b32 s38, s37, 4
    s_and_b32 s37, s37, 15
    v_xor_b32 v17, s38, v9
    v_lshlrev_b32 v17, 4, v17
    v_add3_u32 v17, v17, v8, s37
    v_add_f32 v22, s33, v86
    v_add_f32 v23, s33, v94
    v_rcp_f32 v22, v22
    v_rcp_f32 v23, v23
    v_mul_f32 v80, v80, v22
    v_mul_f32 v81, v81, v22
    v_mul_f32 v82, v82, v22
    v_mul_f32 v83, v83, v22
    v_mul_f32 v84, v84, v22
    v_mul_f32 v85, v85, v22
    v_mul_f32 v88, v88, v23
    v_mul_f32 v89, v89, v23
    v_mul_f32 v90, v90, v23
    v_mul_f32 v91, v91, v23
    v_mul_f32 v92, v92, v23
    v_mul_f32 v93, v93, v23
    v_cvt_pk_bf16_f32 v32, v80, v81
    v_cvt_pk_bf16_f32 v33, v82, v83
    v_cvt_pk_bf16_f32 v34, v84, v85
    ds_write_b64 v16, v[32:33] offset:0
    v_cvt_pk_bf16_f32 v36, v88, v89
    v_cvt_pk_bf16_f32 v37, v90, v91
    v_cvt_pk_bf16_f32 v38, v92, v93
    ds_write_b64 v16, v[36:37] offset:18432
    s_mov_b64 exec, s[64:65]
    ds_write_b32 v17, v34 offset:0
    ds_write_b32 v17, v38 offset:18432
    s_mov_b64 exec, -1
    s_waitcnt lgkmcnt(8)
    v_cvt_pk_bf16_f32 v40, v40, v41
    v_cvt_pk_bf16_f32 v41, v42, v43
    v_cvt_pk_bf16_f32 v44, v44, v45
    v_cvt_pk_bf16_f32 v45, v46, v47
    v_cvt_pk_bf16_f32 v48, v48, v49
    v_mov_b32 v49, 0
    v_cvt_pk_bf16_f32 v50, v50, v51
    v_mov_b32 v51, 0
    v_and_b32 v54, v10, v54
    v_mov_b32 v55, 0
    v_and_b32 v58, v10, v58
    v_mov_b32 v59, 0
    v_mfma_f32_16x16x16_bf16 v[80:83], v[40:41], v[52:53], 0
    v_mfma_f32_16x16x16_bf16 v[84:87], v[44:45], v[52:53], 0
    v_mfma_f32_16x16x16_bf16 v[88:91], v[40:41], v[56:57], 0
    v_mfma_f32_16x16x16_bf16 v[92:95], v[44:45], v[56:57], 0
    v_mfma_f32_16x16x16_bf16 v[80:83], v[48:49], v[54:55], v[80:83]
    v_mfma_f32_16x16x16_bf16 v[84:87], v[50:51], v[54:55], v[84:87]
    v_mfma_f32_16x16x16_bf16 v[88:91], v[48:49], v[58:59], v[88:91]
    v_mfma_f32_16x16x16_bf16 v[92:95], v[50:51], v[58:59], v[92:95]
    s_mul_i32 s32, s3, 3
    s_add_u32 s32, s32, 1
    s_min_u32 s32, s32, 31
    s_and_b32 s34, s32, 1
    s_mul_i32 s35, s32, 36
    s_lshl_b32 s36, s34, 2
    s_add_u32 s36, s36, s35
    s_xor_b32 s37, s34, 1
    s_lshl_b32 s37, s37, 5
    s_add_u32 s37, s37, s35
    v_lshl_add_u32 v16, v7, 3, s36
    v_lshrrev_b32 v17, 4, v16
    v_xor_b32 v17, v17, v9
    v_and_b32 v16, 15, v16
    v_lshl_add_u32 v16, v17, 4, v16
    v_add_u32 v16, v16, v8
    s_lshr_b32 s38, s37, 4
    s_and_b32 s37, s37, 15
    v_xor_b32 v17, s38, v9
    v_lshlrev_b32 v17, 4, v17
    v_add3_u32 v17, v17, v8, s37
    v_add_f32 v42, s33, v86
    v_add_f32 v43, s33, v94
    v_rcp_f32 v42, v42
    v_rcp_f32 v43, v43
    v_mul_f32 v80, v80, v42
    v_mul_f32 v81, v81, v42
    v_mul_f32 v82, v82, v42
    v_mul_f32 v83, v83, v42
    v_mul_f32 v84, v84, v42
    v_mul_f32 v85, v85, v42
    v_mul_f32 v88, v88, v43
    v_mul_f32 v89, v89, v43
    v_mul_f32 v90, v90, v43
    v_mul_f32 v91, v91, v43
    v_mul_f32 v92, v92, v43
    v_mul_f32 v93, v93, v43
    v_cvt_pk_bf16_f32 v52, v80, v81
    v_cvt_pk_bf16_f32 v53, v82, v83
    v_cvt_pk_bf16_f32 v54, v84, v85
    ds_write_b64 v16, v[52:53] offset:0
    v_cvt_pk_bf16_f32 v56, v88, v89
    v_cvt_pk_bf16_f32 v57, v90, v91
    v_cvt_pk_bf16_f32 v58, v92, v93
    ds_write_b64 v16, v[56:57] offset:18432
    s_mov_b64 exec, s[64:65]
    ds_write_b32 v17, v54 offset:0
    ds_write_b32 v17, v58 offset:18432
    s_mov_b64 exec, -1
    s_waitcnt lgkmcnt(0)
    v_cvt_pk_bf16_f32 v60, v60, v61
    v_cvt_pk_bf16_f32 v61, v62, v63
    v_cvt_pk_bf16_f32 v64, v64, v65
    v_cvt_pk_bf16_f32 v65, v66, v67
    v_cvt_pk_bf16_f32 v68, v68, v69
    v_mov_b32 v69, 0
    v_cvt_pk_bf16_f32 v70, v70, v71
    v_mov_b32 v71, 0
    v_and_b32 v74, v10, v74
    v_mov_b32 v75, 0
    v_and_b32 v78, v10, v78
    v_mov_b32 v79, 0
    v_mfma_f32_16x16x16_bf16 v[80:83], v[60:61], v[72:73], 0
    v_mfma_f32_16x16x16_bf16 v[84:87], v[64:65], v[72:73], 0
    v_mfma_f32_16x16x16_bf16 v[88:91], v[60:61], v[76:77], 0
    v_mfma_f32_16x16x16_bf16 v[92:95], v[64:65], v[76:77], 0
    v_mfma_f32_16x16x16_bf16 v[80:83], v[68:69], v[74:75], v[80:83]
    v_mfma_f32_16x16x16_bf16 v[84:87], v[70:71], v[74:75], v[84:87]
    v_mfma_f32_16x16x16_bf16 v[88:91], v[68:69], v[78:79], v[88:91]
    v_mfma_f32_16x16x16_bf16 v[92:95], v[70:71], v[78:79], v[92:95]
    s_mul_i32 s32, s3, 3
    s_add_u32 s32, s32, 2
    s_min_u32 s32, s32, 31
    s_and_b32 s34, s32, 1
    s_mul_i32 s35, s32, 36
    s_lshl_b32 s36, s34, 2
    s_add_u32 s36, s36, s35
    s_xor_b32 s37, s34, 1
    s_lshl_b32 s37, s37, 5
    s_add_u32 s37, s37, s35
    v_lshl_add_u32 v16, v7, 3, s36
    v_lshrrev_b32 v17, 4, v16
    v_xor_b32 v17, v17, v9
    v_and_b32 v16, 15, v16
    v_lshl_add_u32 v16, v17, 4, v16
    v_add_u32 v16, v16, v8
    s_lshr_b32 s38, s37, 4
    s_and_b32 s37, s37, 15
    v_xor_b32 v17, s38, v9
    v_lshlrev_b32 v17, 4, v17
    v_add3_u32 v17, v17, v8, s37
    v_add_f32 v62, s33, v86
    v_add_f32 v63, s33, v94
    v_rcp_f32 v62, v62
    v_rcp_f32 v63, v63
    v_mul_f32 v80, v80, v62
    v_mul_f32 v81, v81, v62
    v_mul_f32 v82, v82, v62
    v_mul_f32 v83, v83, v62
    v_mul_f32 v84, v84, v62
    v_mul_f32 v85, v85, v62
    v_mul_f32 v88, v88, v63
    v_mul_f32 v89, v89, v63
    v_mul_f32 v90, v90, v63
    v_mul_f32 v91, v91, v63
    v_mul_f32 v92, v92, v63
    v_mul_f32 v93, v93, v63
    v_cvt_pk_bf16_f32 v72, v80, v81
    v_cvt_pk_bf16_f32 v73, v82, v83
    v_cvt_pk_bf16_f32 v74, v84, v85
    ds_write_b64 v16, v[72:73] offset:0
    v_cvt_pk_bf16_f32 v76, v88, v89
    v_cvt_pk_bf16_f32 v77, v90, v91
    v_cvt_pk_bf16_f32 v78, v92, v93
    ds_write_b64 v16, v[76:77] offset:18432
    s_mov_b64 exec, s[64:65]
    ds_write_b32 v17, v74 offset:0
    ds_write_b32 v17, v78 offset:18432
    s_mov_b64 exec, -1
    s_cmp_ge_u32 s3, 9
    s_cbranch_scc1 L_p2_nx
    v_and_b32 v12, 15, v1
    v_lshrrev_b32 v13, 4, v1
    v_mul_u32_u24 v12, 1152, v12
    v_lshl_add_u32 v12, v13, 3, v12
    s_mul_i32 s31, s61, 36864
    s_mul_i32 s32, s62, 288
    s_add_u32 s31, s31, s32
    s_lshl_b32 s32, s3, 5
    s_add_u32 s31, s31, s32
    buffer_load_dwordx2 v[60:61], v12, s[8:11], s31 offen
    s_add_u32 s31, s31, 18432
    buffer_load_dwordx2 v[62:63], v12, s[8:11], s31 offen
L_p2_nx:
    s_waitcnt lgkmcnt(0)
    s_branch L_p2_b
L_p2_w11:
    s_mov_b32 s50, 0
    s_mov_b32 s49, 0
    s_mov_b32 s42, 1152
    s_load_dwordx2 s[4:5], s[0:1], 56
    s_mov_b32 s58, s29
    s_mov_b32 s60, s30
    s_cmp_lt_u32 s30, 27
    s_cselect_b32 s50, 1, 0
    s_mul_i32 s52, s60, 57
    s_lshr_b32 s52, s52, 9
    s_mul_i32 s53, s52, 9
    s_sub_u32 s53, s60, s53
    s_lshl_b32 s54, s53, 2
    s_add_u32 s54, s54, 0
    s_mul_i32 s55, s54, 43
    s_lshr_b32 s55, s55, 7
    s_mul_i32 s56, s55, 3
    s_sub_u32 s56, s54, s56
    s_mul_i32 s57, s58, 12
    s_add_u32 s57, s57, s55
    s_mul_i32 s57, s57, 55296
    s_lshl_b32 s56, s56, 10
    s_add_u32 s57, s57, s56
    s_mul_i32 s56, s52, 18432
    s_add_u32 s57, s57, s56
    s_add_u32 s44, s57, 0x1200000
    s_lshl_b32 s54, s53, 2
    s_add_u32 s54, s54, 1
    s_mul_i32 s55, s54, 43
    s_lshr_b32 s55, s55, 7
    s_mul_i32 s56, s55, 3
    s_sub_u32 s56, s54, s56
    s_mul_i32 s57, s58, 12
    s_add_u32 s57, s57, s55
    s_mul_i32 s57, s57, 55296
    s_lshl_b32 s56, s56, 10
    s_add_u32 s57, s57, s56
    s_mul_i32 s56, s52, 18432
    s_add_u32 s57, s57, s56
    s_add_u32 s45, s57, 0x1200000
    s_lshl_b32 s54, s53, 2
    s_add_u32 s54, s54, 2
    s_mul_i32 s55, s54, 43
    s_lshr_b32 s55, s55, 7
    s_mul_i32 s56, s55, 3
    s_sub_u32 s56, s54, s56
    s_mul_i32 s57, s58, 12
    s_add_u32 s57, s57, s55
    s_mul_i32 s57, s57, 55296
    s_lshl_b32 s56, s56, 10
    s_add_u32 s57, s57, s56
    s_mul_i32 s56, s52, 18432
    s_add_u32 s57, s57, s56
    s_add_u32 s46, s57, 0x1200000
    s_lshl_b32 s54, s53, 2
    s_add_u32 s54, s54, 3
    s_mul_i32 s55, s54, 43
    s_lshr_b32 s55, s55, 7
    s_mul_i32 s56, s55, 3
    s_sub_u32 s56, s54, s56
    s_mul_i32 s57, s58, 12
    s_add_u32 s57, s57, s55
    s_mul_i32 s57, s57, 55296
    s_lshl_b32 s56, s56, 10
    s_add_u32 s57, s57, s56
    s_mul_i32 s56, s52, 18432
    s_add_u32 s57, s57, s56
    s_add_u32 s47, s57, 0x1200000
    s_mov_b32 s48, 3072
    s_waitcnt lgkmcnt(0)
    s_mov_b32 s24, s4
    s_mov_b32 s25, s5
    s_mov_b32 s26, 0x510000
    s_mov_b32 s27, 0x20000
    s_mul_i32 s43, s58, 663552
    s_mul_i32 s54, s52, 221184
    s_add_u32 s43, s43, s54
    s_lshl_b32 s54, s53, 7
    s_add_u32 s43, s43, s54
    s_mov_b32 s51, 151552
    s_mov_b32 s73, s50
    s_cmp_eq_u32 s73, 0
    s_cbranch_scc1 L_p2_b
    v_lshrrev_b32 v12, 3, v1
    v_mul_lo_u32 v12, v12, s42
    v_and_b32 v13, 7, v1
    v_lshl_add_u32 v140, v13, 4, v12
    s_mov_b32 s52, s43
    s_lshl_b32 s53, s42, 3
    buffer_load_dwordx4 v[44:47], v140, s[24:27], s52 offen
    s_add_u32 s52, s52, s53
    buffer_load_dwordx4 v[48:51], v140, s[24:27], s52 offen
    s_add_u32 s52, s52, s53
    buffer_load_dwordx4 v[52:55], v140, s[24:27], s52 offen
    s_add_u32 s52, s52, s53
    buffer_load_dwordx4 v[56:59], v140, s[24:27], s52 offen
    s_add_u32 s52, s52, s53
    buffer_load_dwordx4 v[60:63], v140, s[24:27], s52 offen
    s_add_u32 s52, s52, s53
    buffer_load_dwordx4 v[64:67], v140, s[24:27], s52 offen
    s_add_u32 s52, s52, s53
    buffer_load_dwordx4 v[68:71], v140, s[24:27], s52 offen
    s_add_u32 s52, s52, s53
    buffer_load_dwordx4 v[72:75], v140, s[24:27], s52 offen
    s_add_u32 s52, s52, s53
    buffer_load_dwordx4 v[76:79], v140, s[24:27], s52 offen
    s_add_u32 s52, s52, s53
    buffer_load_dwordx4 v[80:83], v140, s[24:27], s52 offen
    s_add_u32 s52, s52, s53
    buffer_load_dwordx4 v[84:87], v140, s[24:27], s52 offen
    s_add_u32 s52, s52, s53
    buffer_load_dwordx4 v[88:91], v140, s[24:27], s52 offen
    s_add_u32 s52, s52, s53
    buffer_load_dwordx4 v[92:95], v140, s[24:27], s52 offen
    s_add_u32 s52, s52, s53
    buffer_load_dwordx4 v[96:99], v140, s[24:27], s52 offen
    s_add_u32 s52, s52, s53
    buffer_load_dwordx4 v[100:103], v140, s[24:27], s52 offen
    s_add_u32 s52, s52, s53
    buffer_load_dwordx4 v[104:107], v140, s[24:27], s52 offen
    s_add_u32 s52, s52, s53
    buffer_load_dwordx4 v[108:111], v140, s[24:27], s52 offen
    s_add_u32 s52, s52, s53
    buffer_load_dwordx4 v[112:115], v140, s[24:27], s52 offen
    s_add_u32 s52, s52, s53
    buffer_load_dwordx4 v[116:119], v140, s[24:27], s52 offen
    s_add_u32 s52, s52, s53
    buffer_load_dwordx4 v[120:123], v140, s[24:27], s52 offen
    s_add_u32 s52, s52, s53
    buffer_load_dwordx4 v[124:127], v140, s[24:27], s52 offen
    s_add_u32 s52, s52, s53
    buffer_load_dwordx4 v[128:131], v140, s[24:27], s52 offen
    s_add_u32 s52, s52, s53
    buffer_load_dwordx4 v[132:135], v140, s[24:27], s52 offen
    s_add_u32 s52, s52, s53
    buffer_load_dwordx4 v[136:139], v140, s[24:27], s52 offen
    s_add_u32 s52, s52, s53
L_p2_b:
    s_barrier
    s_cmp_ge_u32 s3, 9
    s_cbranch_scc1 L_p2_c
    v_and_b32 v12, 15, v1
    v_lshrrev_b32 v13, 4, v1
    v_and_b32 v14, 7, v12
    v_mul_u32_u24 v15, 1152, v12
    v_xor_b32 v16, v13, v14
    v_lshl_add_u32 v8, v16, 4, v15
    v_or_b32 v16, 4, v13
    v_xor_b32 v16, v16, v14
    v_lshl_add_u32 v9, v16, 4, v15
    s_mul_i32 s40, s62, 9
    s_add_u32 s40, s40, s3
    s_mul_i32 s40, s40, 18432
    s_add_u32 s40, s40, 0xaa2000
    ds_read_b128 v[20:23], v8 offset:0
    ds_read_b128 v[24:27], v8 offset:18432
    ds_read_b128 v[28:31], v9 offset:0
    ds_read_b128 v[32:35], v9 offset:18432
    ds_read_b128 v[36:39], v8 offset:128
    ds_read_b128 v[40:43], v8 offset:18560
    ds_read_b128 v[44:47], v9 offset:128
    ds_read_b128 v[48:51], v9 offset:18560
    s_waitcnt lgkmcnt(6)
    v_mfma_f32_16x16x32_bf16 v[52:55], v[96:99], v[20:23], 0
    v_mfma_f32_16x16x32_bf16 v[56:59], v[96:99], v[24:27], 0
    ds_read_b128 v[20:23], v8 offset:256
    ds_read_b128 v[24:27], v8 offset:18688
    s_waitcnt lgkmcnt(6)
    v_mfma_f32_16x16x32_bf16 v[52:55], v[100:103], v[28:31], v[52:55]
    v_mfma_f32_16x16x32_bf16 v[56:59], v[100:103], v[32:35], v[56:59]
    buffer_load_dwordx4 v[96:99], v3, s[16:19], s40 offen offset:0 sc1
    ds_read_b128 v[28:31], v9 offset:256
    ds_read_b128 v[32:35], v9 offset:18688
    s_waitcnt lgkmcnt(6)
    v_mfma_f32_16x16x32_bf16 v[52:55], v[104:107], v[36:39], v[52:55]
    v_mfma_f32_16x16x32_bf16 v[56:59], v[104:107], v[40:43], v[56:59]
    ds_read_b128 v[36:39], v8 offset:384
    ds_read_b128 v[40:43], v8 offset:18816
    s_waitcnt lgkmcnt(6)
    v_mfma_f32_16x16x32_bf16 v[52:55], v[108:111], v[44:47], v[52:55]
    v_mfma_f32_16x16x32_bf16 v[56:59], v[108:111], v[48:51], v[56:59]
    buffer_load_dwordx4 v[100:103], v3, s[16:19], s40 offen offset:1024 sc1
    ds_read_b128 v[44:47], v9 offset:384
    ds_read_b128 v[48:51], v9 offset:18816
    s_waitcnt lgkmcnt(6)
    v_mfma_f32_16x16x32_bf16 v[52:55], v[112:115], v[20:23], v[52:55]
    v_mfma_f32_16x16x32_bf16 v[56:59], v[112:115], v[24:27], v[56:59]
    ds_read_b128 v[20:23], v8 offset:512
    ds_read_b128 v[24:27], v8 offset:18944
    s_waitcnt lgkmcnt(6)
    v_mfma_f32_16x16x32_bf16 v[52:55], v[116:119], v[28:31], v[52:55]
    v_mfma_f32_16x16x32_bf16 v[56:59], v[116:119], v[32:35], v[56:59]
    buffer_load_dwordx4 v[104:107], v3, s[16:19], s40 offen offset:2048 sc1
    ds_read_b128 v[28:31], v9 offset:512
    ds_read_b128 v[32:35], v9 offset:18944
    s_waitcnt lgkmcnt(6)
    v_mfma_f32_16x16x32_bf16 v[52:55], v[120:123], v[36:39], v[52:55]
    v_mfma_f32_16x16x32_bf16 v[56:59], v[120:123], v[40:43], v[56:59]
    ds_read_b128 v[36:39], v8 offset:640
    ds_read_b128 v[40:43], v8 offset:19072
    s_waitcnt lgkmcnt(6)
    v_mfma_f32_16x16x32_bf16 v[52:55], v[124:127], v[44:47], v[52:55]
    v_mfma_f32_16x16x32_bf16 v[56:59], v[124:127], v[48:51], v[56:59]
    buffer_load_dwordx4 v[108:111], v3, s[16:19], s40 offen offset:3072 sc1
    s_add_u32 s40, s40, 4096
    ds_read_b128 v[44:47], v9 offset:640
    ds_read_b128 v[48:51], v9 offset:19072
    s_waitcnt lgkmcnt(6)
    v_mfma_f32_16x16x32_bf16 v[52:55], v[128:131], v[20:23], v[52:55]
    v_mfma_f32_16x16x32_bf16 v[56:59], v[128:131], v[24:27], v[56:59]
    ds_read_b128 v[20:23], v8 offset:768
    ds_read_b128 v[24:27], v8 offset:19200
    s_waitcnt lgkmcnt(6)
    v_mfma_f32_16x16x32_bf16 v[52:55], v[132:135], v[28:31], v[52:55]
    v_mfma_f32_16x16x32_bf16 v[56:59], v[132:135], v[32:35], v[56:59]
    buffer_load_dwordx4 v[112:115], v3, s[16:19], s40 offen offset:0 sc1
    ds_read_b128 v[28:31], v9 offset:768
    ds_read_b128 v[32:35], v9 offset:19200
    s_waitcnt lgkmcnt(6)
    v_mfma_f32_16x16x32_bf16 v[52:55], v[136:139], v[36:39], v[52:55]
    v_mfma_f32_16x16x32_bf16 v[56:59], v[136:139], v[40:43], v[56:59]
    ds_read_b128 v[36:39], v8 offset:896
    ds_read_b128 v[40:43], v8 offset:19328
    s_waitcnt lgkmcnt(6)
    v_mfma_f32_16x16x32_bf16 v[52:55], v[140:143], v[44:47], v[52:55]
    v_mfma_f32_16x16x32_bf16 v[56:59], v[140:143], v[48:51], v[56:59]
    buffer_load_dwordx4 v[116:119], v3, s[16:19], s40 offen offset:1024 sc1
    ds_read_b128 v[44:47], v9 offset:896
    ds_read_b128 v[48:51], v9 offset:19328
    s_waitcnt lgkmcnt(6)
    v_mfma_f32_16x16x32_bf16 v[52:55], v[144:147], v[20:23], v[52:55]
    v_mfma_f32_16x16x32_bf16 v[56:59], v[144:147], v[24:27], v[56:59]
    ds_read_b128 v[20:23], v8 offset:1024
    ds_read_b128 v[24:27], v8 offset:19456
    s_waitcnt lgkmcnt(6)
    v_mfma_f32_16x16x32_bf16 v[52:55], v[148:151], v[28:31], v[52:55]
    v_mfma_f32_16x16x32_bf16 v[56:59], v[148:151], v[32:35], v[56:59]
    buffer_load_dwordx4 v[120:123], v3, s[16:19], s40 offen offset:2048 sc1
    ds_read_b128 v[28:31], v9 offset:1024
    ds_read_b128 v[32:35], v9 offset:19456
    s_waitcnt lgkmcnt(6)
    v_mfma_f32_16x16x32_bf16 v[52:55], v[152:155], v[36:39], v[52:55]
    v_mfma_f32_16x16x32_bf16 v[56:59], v[152:155], v[40:43], v[56:59]
    s_waitcnt lgkmcnt(4)
    v_mfma_f32_16x16x32_bf16 v[52:55], v[156:159], v[44:47], v[52:55]
    v_mfma_f32_16x16x32_bf16 v[56:59], v[156:159], v[48:51], v[56:59]
    buffer_load_dwordx4 v[124:127], v3, s[16:19], s40 offen offset:3072 sc1
    s_add_u32 s40, s40, 4096
    s_waitcnt lgkmcnt(2)
    v_mfma_f32_16x16x32_bf16 v[52:55], v[160:163], v[20:23], v[52:55]
    v_mfma_f32_16x16x32_bf16 v[56:59], v[160:163], v[24:27], v[56:59]
    s_waitcnt lgkmcnt(0)
    v_mfma_f32_16x16x32_bf16 v[52:55], v[164:167], v[28:31], v[52:55]
    v_mfma_f32_16x16x32_bf16 v[56:59], v[164:167], v[32:35], v[56:59]
    buffer_load_dwordx4 v[128:131], v3, s[16:19], s40 offen offset:0 sc1
    s_waitcnt vmcnt(9)
    s_mov_b32 s52, 0x3f803f80
    v_lshlrev_b32 v12, 16, v60
    v_and_b32 v13, 0xffff0000, v60
    v_lshlrev_b32 v14, 16, v61
    v_and_b32 v15, 0xffff0000, v61
    v_add_f32 v52, v52, v12
    v_add_f32 v53, v53, v13
    v_add_f32 v54, v54, v14
    v_add_f32 v55, v55, v15
    v_cvt_pk_bf16_f32 v60, v52, v53
    v_cvt_pk_bf16_f32 v61, v54, v55
    ds_write_b64 v5, v[60:61] offset:36864
    v_lshlrev_b32 v12, 16, v62
    v_and_b32 v13, 0xffff0000, v62
    v_lshlrev_b32 v14, 16, v63
    v_and_b32 v15, 0xffff0000, v63
    v_add_f32 v56, v56, v12
    v_add_f32 v57, v57, v13
    v_add_f32 v58, v58, v14
    v_add_f32 v59, v59, v15
    v_cvt_pk_bf16_f32 v62, v56, v57
    v_cvt_pk_bf16_f32 v63, v58, v59
    ds_write_b64 v5, v[62:63] offset:41472
    v_mov_b32 v20, 0
    v_mov_b32 v21, 0
    v_dot2_f32_bf16 v20, v60, s52, v20
    v_dot2_f32_bf16 v21, v60, v60, v21
    v_dot2_f32_bf16 v20, v61, s52, v20
    v_dot2_f32_bf16 v21, v61, v61, v21
    v_mov_b32 v22, 0
    v_mov_b32 v23, 0
    v_dot2_f32_bf16 v22, v62, s52, v22
    v_dot2_f32_bf16 v23, v62, v62, v23
    v_dot2_f32_bf16 v22, v63, s52, v22
    v_dot2_f32_bf16 v23, v63, v63, v23
    v_mov_b32 v24, v20
    v_mov_b32 v25, v21
    v_mov_b32 v26, v22
    v_mov_b32 v27, v23
    v_permlane32_swap_b32 v20, v24
    v_permlane32_swap_b32 v21, v25
    v_permlane32_swap_b32 v22, v26
    v_permlane32_swap_b32 v23, v27
    v_add_f32 v20, v20, v24
    v_add_f32 v21, v21, v25
    v_add_f32 v22, v22, v26
    v_add_f32 v23, v23, v27
    v_mov_b32 v24, v20
    v_mov_b32 v25, v21
    v_mov_b32 v26, v22
    v_mov_b32 v27, v23
    v_permlane16_swap_b32 v20, v24
    v_permlane16_swap_b32 v21, v25
    v_permlane16_swap_b32 v22, v26
    v_permlane16_swap_b32 v23, v27
    v_add_f32 v20, v20, v24
    v_add_f32 v21, v21, v25
    v_add_f32 v22, v22, v26
    v_add_f32 v23, v23, v27
    s_mov_b64 exec, s[64:65]
    ds_write_b64 v6, v[20:21] offset:0
    ds_write_b64 v6, v[22:23] offset:128
    s_mov_b64 exec, -1
    s_waitcnt lgkmcnt(0)
L_p2_c:
    s_barrier
    s_cmp_ge_u32 s3, 9
    s_cbranch_scc1 Lcs9_25
    v_lshlrev_b32 v12, 4, v0
    v_add_u32 v13, 36864, v12
    ds_read_b128 v[16:19], v13
    s_mul_i32 s31, s62, 589824
    s_mul_i32 s32, s61, 9216
    s_add_u32 s31, s31, s32
    s_add_u32 s31, s31, 0x340000
    s_waitcnt lgkmcnt(0)
    buffer_store_dwordx4 v[16:19], v12, s[16:19], s31 offen sc1
    s_branch Lcsd_26
Lcs9_25:
    s_cmp_eq_u32 s3, 9
    s_cbranch_scc0 Lcsd_26
    s_mov_b32 exec_lo, -1
    s_mov_b32 exec_hi, 0
    v_lshlrev_b32 v12, 3, v1
    v_add_u32 v13, 55296, v12
    ds_read_b64 v[20:21], v13 offset:0
    ds_read_b64 v[22:23], v13 offset:256
    ds_read_b64 v[24:25], v13 offset:512
    ds_read_b64 v[26:27], v13 offset:768
    ds_read_b64 v[28:29], v13 offset:1024
    ds_read_b64 v[30:31], v13 offset:1280
    ds_read_b64 v[32:33], v13 offset:1536
    ds_read_b64 v[34:35], v13 offset:1792
    ds_read_b64 v[36:37], v13 offset:2048
    s_lshl_b32 s31, s63, 8
    s_add_u32 s31, s31, 0x40000
    s_waitcnt lgkmcnt(0)
    v_pk_add_f32 v[20:21], v[20:21], v[22:23]
    v_pk_add_f32 v[20:21], v[20:21], v[24:25]
    v_pk_add_f32 v[20:21], v[20:21], v[26:27]
    v_pk_add_f32 v[20:21], v[20:21], v[28:29]
    v_pk_add_f32 v[20:21], v[20:21], v[30:31]
    v_pk_add_f32 v[20:21], v[20:21], v[32:33]
    v_pk_add_f32 v[20:21], v[20:21], v[34:35]
    v_pk_add_f32 v[20:21], v[20:21], v[36:37]
    buffer_store_dwordx2 v[20:21], v12, s[16:19], s31 offen sc1
    s_mov_b64 exec, -1
Lcsd_26:
    s_waitcnt vmcnt(0)
    s_barrier
    s_cmp_eq_u32 s3, 11
    s_cbranch_scc0 L_p2_f
    s_lshl_b32 s31, s63, 7
    s_mov_b64 exec, 1
    v_mov_b32 v12, s28
    v_mov_b32 v13, 0x10000
    buffer_store_dword v12, v13, s[16:19], s31 offen sc1
    s_mov_b64 exec, -1
L_p2_f:
    s_cmp_ge_u32 s3, 9
    s_cbranch_scc1 L_p2b_nw
    s_mul_i32 s31, s62, 9
    s_add_u32 s31, s31, s3
    s_mul_i32 s31, s31, 18432
    s_add_u32 s31, s31, 0xaa4400
    buffer_load_dwordx4 v[132:135], v3, s[16:19], s31 offen offset:0 sc1
    buffer_load_dwordx4 v[136:139], v3, s[16:19], s31 offen offset:1024 sc1
    buffer_load_dwordx4 v[140:143], v3, s[16:19], s31 offen offset:2048 sc1
    buffer_load_dwordx4 v[144:147], v3, s[16:19], s31 offen offset:3072 sc1
    s_add_u32 s31, s31, 4096
    buffer_load_dwordx4 v[148:151], v3, s[16:19], s31 offen offset:0 sc1
    buffer_load_dwordx4 v[152:155], v3, s[16:19], s31 offen offset:1024 sc1
    buffer_load_dwordx4 v[156:159], v3, s[16:19], s31 offen offset:2048 sc1
    buffer_load_dwordx4 v[160:163], v3, s[16:19], s31 offen offset:3072 sc1
    s_add_u32 s31, s31, 4096
    buffer_load_dwordx4 v[164:167], v3, s[16:19], s31 offen offset:0 sc1
L_p2b_nw:
    s_cmp_eq_u32 s3, 10
    s_cbranch_scc0 L_p2b_nc
    s_mov_b32 exec_lo, -1
    s_mov_b32 exec_hi, 0xf
    s_mul_i32 s31, s62, 576
    s_add_u32 s31, s31, 0x60000
    buffer_load_dwordx4 v[20:23], v3, s[16:19], s31 offen sc1
    buffer_load_dwordx4 v[24:27], v3, s[16:19], s31 offen offset:2304 sc1
    s_add_u32 s31, s31, 4608
    buffer_load_dwordx4 v[28:31], v3, s[16:19], s31 offen sc1
    s_waitcnt vmcnt(0)
    v_pk_add_f32 v[20:21], v[20:21], v[24:25]
    v_pk_add_f32 v[20:21], v[20:21], v[28:29]
    v_pk_add_f32 v[22:23], v[22:23], v[26:27]
    v_pk_add_f32 v[22:23], v[22:23], v[30:31]
    v_add_u32 v12, 58112, v3
    ds_write_b128 v12, v[20:23]
    s_mov_b64 exec, -1
L_p2b_nc:
    s_cmp_eq_u32 s3, 11
    s_cbranch_scc0 L_p2b_np
    s_lshl_b32 s31, s61, 9
    s_add_u32 s31, s31, 0x10000
    v_lshlrev_b32 v12, 7, v1
    v_add_u32 v12, s31, v12
    s_mov_b32 exec_lo, 0xf
    s_mov_b32 exec_hi, 0x0
    s_mov_b32 s72, 0x40000
Lpoll_27:
    buffer_load_dword v13, v12, s[16:19], 0 offen sc1
    s_waitcnt vmcnt(0)
    v_cmp_ne_u32 vcc, s28, v13
    s_cbranch_vccz Lpolld_28
    s_sub_u32 s72, s72, 1
    s_cbranch_scc1 Lpolld_28
    s_sleep 2
    s_branch Lpoll_27
Lpolld_28:
    s_mov_b64 exec, -1
    s_waitcnt lgkmcnt(0)
L_p2b_np:
    s_barrier
    s_cmp_ge_u32 s3, 9
    s_cbranch_scc1 L_p2b_b
    s_mul_i32 s33, s61, 9216
    s_add_u32 s33, s33, 0x340000
    s_lshl_b32 s31, s3, 10
    s_mov_b32 m0, s31
    s_add_u32 s31, s31, 9216
    buffer_load_dwordx4 v4, s[16:19], s33 offen sc1 lds
    s_add_u32 s33, s33, 2304
    s_mov_b32 m0, s31
    s_add_u32 s31, s31, 9216
    buffer_load_dwordx4 v4, s[16:19], s33 offen sc1 lds
    s_add_u32 s33, s33, 2304
    s_mov_b32 m0, s31
    s_add_u32 s31, s31, 9216
    buffer_load_dwordx4 v4, s[16:19], s33 offen sc1 lds
    s_add_u32 s33, s33, 2304
    s_mov_b32 m0, s31
    s_add_u32 s31, s31, 9216
    buffer_load_dwordx4 v4, s[16:19], s33 offen sc1 lds
    s_add_u32 s33, s33, 2304
    s_waitcnt vmcnt(0)
L_p2b_b:
    s_cmp_eq_u32 s3, 9
    s_cbranch_scc0 L_p2b_ns
    s_mov_b32 exec_lo, -1
    s_mov_b32 exec_hi, 0
    v_lshlrev_b32 v12, 3, v1
    s_lshl_b32 s31, s61, 10
    s_add_u32 s31, s31, 0x40000
    buffer_load_dwordx2 v[20:21], v12, s[16:19], s31 offen offset:0 sc1
    buffer_load_dwordx2 v[22:23], v12, s[16:19], s31 offen offset:256 sc1
    buffer_load_dwordx2 v[24:25], v12, s[16:19], s31 offen offset:512 sc1
    buffer_load_dwordx2 v[26:27], v12, s[16:19], s31 offen offset:768 sc1
    s_waitcnt vmcnt(0)
    v_pk_add_f32 v[20:21], v[20:21], v[22:23]
    v_pk_add_f32 v[24:25], v[24:25], v[26:27]
    v_pk_add_f32 v[20:21], v[20:21], v[24:25]
    v_mul_f32 v28, 0x3ae38e39, v20
    v_mul_f32 v21, 0x3ae38e39, v21
    v_fma_f32 v21, -v28, v28, v21
    v_max_f32 v21, 0, v21
    v_add_f32 v22, 0x3727c5ac, v21
    v_rsq_f32 v30, v22
    s_nop 0
    v_mul_f32 v22, v30, v30
    v_mul_f32 v22, v22, v21
    v_add_f32 v22, 0x3727c5ac, v22
    v_rsq_f32 v22, v22
    s_nop 0
    v_mul_f32 v29, v30, v22
    v_mov_b32 v31, 0
    v_lshlrev_b32 v12, 4, v1
    v_add_u32 v12, 57600, v12
    ds_write_b128 v12, v[28:31]
    s_mov_b64 exec, -1
L_p2b_ns:
    s_waitcnt lgkmcnt(0)
    s_barrier
    s_cmp_ge_u32 s3, 9
    s_cbranch_scc1 L_p2b_h
    v_and_b32 v12, 15, v1
    v_lshrrev_b32 v13, 4, v1
    v_and_b32 v14, 7, v12
    v_mul_u32_u24 v15, 1152, v12
    v_xor_b32 v16, v13, v14
    v_lshl_add_u32 v8, v16, 4, v15
    v_or_b32 v16, 4, v13
    v_xor_b32 v16, v16, v14
    v_lshl_add_u32 v9, v16, 4, v15
    s_mul_i32 s40, s62, 9
    s_add_u32 s40, s40, s3
    s_mul_i32 s40, s40, 18432
    s_add_u32 s40, s40, 0xb44000
    ds_read_b128 v[20:23], v8 offset:0
    ds_read_b128 v[24:27], v8 offset:18432
    ds_read_b128 v[28:31], v9 offset:0
    ds_read_b128 v[32:35], v9 offset:18432
    ds_read_b128 v[36:39], v8 offset:128
    ds_read_b128 v[40:43], v8 offset:18560
    ds_read_b128 v[44:47], v9 offset:128
    ds_read_b128 v[48:51], v9 offset:18560
    s_waitcnt lgkmcnt(6)
    v_mfma_f32_16x16x32_bf16 v[52:55], v[96:99], v[20:23], 0
    v_mfma_f32_16x16x32_bf16 v[56:59], v[96:99], v[24:27], 0
    ds_read_b128 v[20:23], v8 offset:256
    ds_read_b128 v[24:27], v8 offset:18688
    s_waitcnt lgkmcnt(6)
    v_mfma_f32_16x16x32_bf16 v[52:55], v[100:103], v[28:31], v[52:55]
    v_mfma_f32_16x16x32_bf16 v[56:59], v[100:103], v[32:35], v[56:59]
    buffer_load_dwordx4 v[96:99], v3, s[16:19], s40 offen offset:0 sc1
    ds_read_b128 v[28:31], v9 offset:256
    ds_read_b128 v[32:35], v9 offset:18688
    s_waitcnt lgkmcnt(6)
    v_mfma_f32_16x16x32_bf16 v[52:55], v[104:107], v[36:39], v[52:55]
    v_mfma_f32_16x16x32_bf16 v[56:59], v[104:107], v[40:43], v[56:59]
    ds_read_b128 v[36:39], v8 offset:384
    ds_read_b128 v[40:43], v8 offset:18816
    s_waitcnt lgkmcnt(6)
    v_mfma_f32_16x16x32_bf16 v[52:55], v[108:111], v[44:47], v[52:55]
    v_mfma_f32_16x16x32_bf16 v[56:59], v[108:111], v[48:51], v[56:59]
    buffer_load_dwordx4 v[100:103], v3, s[16:19], s40 offen offset:1024 sc1
    ds_read_b128 v[44:47], v9 offset:384
    ds_read_b128 v[48:51], v9 offset:18816
    s_waitcnt lgkmcnt(6)
    v_mfma_f32_16x16x32_bf16 v[52:55], v[112:115], v[20:23], v[52:55]
    v_mfma_f32_16x16x32_bf16 v[56:59], v[112:115], v[24:27], v[56:59]
    ds_read_b128 v[20:23], v8 offset:512
    ds_read_b128 v[24:27], v8 offset:18944
    s_waitcnt lgkmcnt(6)
    v_mfma_f32_16x16x32_bf16 v[52:55], v[116:119], v[28:31], v[52:55]
    v_mfma_f32_16x16x32_bf16 v[56:59], v[116:119], v[32:35], v[56:59]
    buffer_load_dwordx4 v[104:107], v3, s[16:19], s40 offen offset:2048 sc1
    ds_read_b128 v[28:31], v9 offset:512
    ds_read_b128 v[32:35], v9 offset:18944
    s_waitcnt lgkmcnt(6)
    v_mfma_f32_16x16x32_bf16 v[52:55], v[120:123], v[36:39], v[52:55]
    v_mfma_f32_16x16x32_bf16 v[56:59], v[120:123], v[40:43], v[56:59]
    ds_read_b128 v[36:39], v8 offset:640
    ds_read_b128 v[40:43], v8 offset:19072
    s_waitcnt lgkmcnt(6)
    v_mfma_f32_16x16x32_bf16 v[52:55], v[124:127], v[44:47], v[52:55]
    v_mfma_f32_16x16x32_bf16 v[56:59], v[124:127], v[48:51], v[56:59]
    buffer_load_dwordx4 v[108:111], v3, s[16:19], s40 offen offset:3072 sc1
    s_add_u32 s40, s40, 4096
    ds_read_b128 v[44:47], v9 offset:640
    ds_read_b128 v[48:51], v9 offset:19072
    s_waitcnt lgkmcnt(6)
    v_mfma_f32_16x16x32_bf16 v[52:55], v[128:131], v[20:23], v[52:55]
    v_mfma_f32_16x16x32_bf16 v[56:59], v[128:131], v[24:27], v[56:59]
    ds_read_b128 v[20:23], v8 offset:768
    ds_read_b128 v[24:27], v8 offset:19200
    s_waitcnt lgkmcnt(6)
    v_mfma_f32_16x16x32_bf16 v[52:55], v[132:135], v[28:31], v[52:55]
    v_mfma_f32_16x16x32_bf16 v[56:59], v[132:135], v[32:35], v[56:59]
    buffer_load_dwordx4 v[112:115], v3, s[16:19], s40 offen offset:0 sc1
    ds_read_b128 v[28:31], v9 offset:768
    ds_read_b128 v[32:35], v9 offset:19200
    s_waitcnt lgkmcnt(6)
    v_mfma_f32_16x16x32_bf16 v[52:55], v[136:139], v[36:39], v[52:55]
    v_mfma_f32_16x16x32_bf16 v[56:59], v[136:139], v[40:43], v[56:59]
    ds_read_b128 v[36:39], v8 offset:896
    ds_read_b128 v[40:43], v8 offset:19328
    s_waitcnt lgkmcnt(6)
    v_mfma_f32_16x16x32_bf16 v[52:55], v[140:143], v[44:47], v[52:55]
    v_mfma_f32_16x16x32_bf16 v[56:59], v[140:143], v[48:51], v[56:59]
    buffer_load_dwordx4 v[116:119], v3, s[16:19], s40 offen offset:1024 sc1
    ds_read_b128 v[44:47], v9 offset:896
    ds_read_b128 v[48:51], v9 offset:19328
    s_waitcnt lgkmcnt(6)
    v_mfma_f32_16x16x32_bf16 v[52:55], v[144:147], v[20:23], v[52:55]
    v_mfma_f32_16x16x32_bf16 v[56:59], v[144:147], v[24:27], v[56:59]
    ds_read_b128 v[20:23], v8 offset:1024
    ds_read_b128 v[24:27], v8 offset:19456
    s_waitcnt lgkmcnt(6)
    v_mfma_f32_16x16x32_bf16 v[52:55], v[148:151], v[28:31], v[52:55]
    v_mfma_f32_16x16x32_bf16 v[56:59], v[148:151], v[32:35], v[56:59]
    buffer_load_dwordx4 v[120:123], v3, s[16:19], s40 offen offset:2048 sc1
    ds_read_b128 v[28:31], v9 offset:1024
    ds_read_b128 v[32:35], v9 offset:19456
    s_waitcnt lgkmcnt(6)
    v_mfma_f32_16x16x32_bf16 v[52:55], v[152:155], v[36:39], v[52:55]
    v_mfma_f32_16x16x32_bf16 v[56:59], v[152:155], v[40:43], v[56:59]
    s_waitcnt lgkmcnt(4)
    v_mfma_f32_16x16x32_bf16 v[52:55], v[156:159], v[44:47], v[52:55]
    v_mfma_f32_16x16x32_bf16 v[56:59], v[156:159], v[48:51], v[56:59]
    buffer_load_dwordx4 v[124:127], v3, s[16:19], s40 offen offset:3072 sc1
    s_add_u32 s40, s40, 4096
    s_waitcnt lgkmcnt(2)
    v_mfma_f32_16x16x32_bf16 v[52:55], v[160:163], v[20:23], v[52:55]
    v_mfma_f32_16x16x32_bf16 v[56:59], v[160:163], v[24:27], v[56:59]
    s_waitcnt lgkmcnt(0)
    v_mfma_f32_16x16x32_bf16 v[52:55], v[164:167], v[28:31], v[52:55]
    v_mfma_f32_16x16x32_bf16 v[56:59], v[164:167], v[32:35], v[56:59]
    buffer_load_dwordx4 v[128:131], v3, s[16:19], s40 offen offset:0 sc1
    v_and_b32 v12, 15, v1
    v_lshlrev_b32 v12, 4, v12
    ds_read_b128 v[64:67], v12 offset:57600
    ds_read_b128 v[68:71], v12 offset:57856
    v_lshrrev_b32 v12, 4, v1
    v_lshlrev_b32 v12, 4, v12
    s_lshl_b32 s31, s3, 6
    v_add_u32 v12, s31, v12
    ds_read_b128 v[72:75], v12 offset:58112
    s_mov_b32 s54, 0xbdd2d3e8
    s_mov_b32 s55, 0xbdd2d3e8
    s_mov_b32 s58, 1.0
    s_mov_b32 s59, 1.0
    v_mov_b32 v18, 0xc0135761
    v_mov_b32 v19, 0xc0135761
    s_waitcnt lgkmcnt(0)
    v_fma_f32 v52, -v64, v72, v52
    v_fma_f32 v53, -v64, v73, v53
    v_fma_f32 v54, -v64, v74, v54
    v_fma_f32 v55, -v64, v75, v55
    v_mul_f32 v52, v52, v65
    v_mul_f32 v53, v53, v65
    v_mul_f32 v54, v54, v65
    v_mul_f32 v55, v55, v65
    v_fma_f32 v56, -v68, v72, v56
    v_fma_f32 v57, -v68, v73, v57
    v_fma_f32 v58, -v68, v74, v58
    v_fma_f32 v59, -v68, v75, v59
    v_mul_f32 v56, v56, v69
    v_mul_f32 v57, v57, v69
    v_mul_f32 v58, v58, v69
    v_mul_f32 v59, v59, v69
    v_pk_mul_f32 v[20:21], v[52:53], v[52:53]
    v_pk_mul_f32 v[22:23], v[54:55], v[54:55]
    v_pk_mul_f32 v[24:25], v[56:57], v[56:57]
    v_pk_mul_f32 v[26:27], v[58:59], v[58:59]
    v_pk_fma_f32 v[20:21], v[20:21], s[54:55], v[18:19]
    v_pk_fma_f32 v[22:23], v[22:23], s[54:55], v[18:19]
    v_pk_fma_f32 v[24:25], v[24:25], s[54:55], v[18:19]
    v_pk_fma_f32 v[26:27], v[26:27], s[54:55], v[18:19]
    v_pk_mul_f32 v[20:21], v[20:21], v[52:53]
    v_pk_mul_f32 v[22:23], v[22:23], v[54:55]
    v_pk_mul_f32 v[24:25], v[24:25], v[56:57]
    v_pk_mul_f32 v[26:27], v[26:27], v[58:59]
    v_exp_f32 v20, v20
    v_exp_f32 v21, v21
    v_exp_f32 v22, v22
    v_exp_f32 v23, v23
    v_exp_f32 v24, v24
    v_exp_f32 v25, v25
    v_exp_f32 v26, v26
    v_exp_f32 v27, v27
    v_pk_add_f32 v[20:21], v[20:21], s[58:59]
    v_pk_add_f32 v[22:23], v[22:23], s[58:59]
    v_pk_add_f32 v[24:25], v[24:25], s[58:59]
    v_pk_add_f32 v[26:27], v[26:27], s[58:59]
    v_rcp_f32 v20, v20
    v_rcp_f32 v21, v21
    v_rcp_f32 v22, v22
    v_rcp_f32 v23, v23
    v_rcp_f32 v24, v24
    v_rcp_f32 v25, v25
    v_rcp_f32 v26, v26
    v_rcp_f32 v27, v27
    v_pk_mul_f32 v[52:53], v[52:53], v[20:21]
    v_pk_mul_f32 v[54:55], v[54:55], v[22:23]
    v_pk_mul_f32 v[56:57], v[56:57], v[24:25]
    v_pk_mul_f32 v[58:59], v[58:59], v[26:27]
    v_cvt_pk_bf16_f32 v60, v52, v53
    v_cvt_pk_bf16_f32 v61, v54, v55
    ds_write_b64 v5, v[60:61] offset:46080
    v_cvt_pk_bf16_f32 v62, v56, v57
    v_cvt_pk_bf16_f32 v63, v58, v59
    ds_write_b64 v5, v[62:63] offset:50688
    s_waitcnt lgkmcnt(0)
    s_branch L_p2b_c
L_p2b_h:
    s_cmp_eq_u32 s3, 10
    s_cbranch_scc0 L_p2b_h10
    s_and_b32 s31, s29, 3
    s_lshl_b32 s31, s31, 8
    s_add_u32 s31, s31, 0x3f000
    v_lshlrev_b32 v12, 7, v1
    v_add_u32 v12, s31, v12
    s_mov_b32 exec_lo, 0x3
    s_mov_b32 exec_hi, 0x0
    s_mov_b32 s72, 0x40000
Lpoll_29:
    buffer_load_dword v13, v12, s[16:19], 0 offen sc1
    s_waitcnt vmcnt(0)
    v_cmp_ne_u32 vcc, s28, v13
    s_cbranch_vccz Lpolld_30
    s_sub_u32 s72, s72, 1
    s_cbranch_scc1 Lpolld_30
    s_sleep 2
    s_branch Lpoll_29
Lpolld_30:
    s_mov_b64 exec, -1
L_p2b_h10:
    s_cmp_eq_u32 s3, 11
    s_cbranch_scc0 L_p2b_c
    s_cmp_eq_u32 s73, 1
    s_cbranch_scc0 L_p2b_c
    v_lshrrev_b32 v12, 3, v1
    v_mul_u32_u24 v12, 144, v12
    v_and_b32 v13, 7, v1
    v_lshl_add_u32 v141, v13, 4, v12
    v_add_u32 v141, s51, v141
    v_lshrrev_b32 v12, 4, v1
    v_lshlrev_b32 v12, 3, v12
    v_bfe_u32 v13, v1, 2, 2
    v_add_u32 v12, v12, v13
    v_mul_u32_u24 v12, 144, v12
    v_and_b32 v13, 3, v1
    v_lshl_add_u32 v142, v13, 3, v12
    v_add_u32 v142, s51, v142
    v_mov_b32 v36, 0
    v_mov_b32 v37, 0
    v_mov_b32 v38, 0
    v_mov_b32 v39, 0
    s_mov_b32 s54, 0x3f803f80
    s_waitcnt vmcnt(20)
    ds_write_b128 v141, v[44:47] offset:0
    ds_write_b128 v141, v[48:51] offset:1152
    ds_write_b128 v141, v[52:55] offset:2304
    ds_write_b128 v141, v[56:59] offset:3456
    s_waitcnt lgkmcnt(0)
    ds_read_b64_tr_b16 v[44:45], v142 offset:0
    ds_read_b64_tr_b16 v[46:47], v142 offset:576
    ds_read_b64_tr_b16 v[48:49], v142 offset:32
    ds_read_b64_tr_b16 v[50:51], v142 offset:608
    ds_read_b64_tr_b16 v[52:53], v142 offset:64
    ds_read_b64_tr_b16 v[54:55], v142 offset:640
    ds_read_b64_tr_b16 v[56:57], v142 offset:96
    ds_read_b64_tr_b16 v[58:59], v142 offset:672
    s_waitcnt lgkmcnt(0)
    v_dot2_f32_bf16 v36, v44, s54, v36
    v_dot2_f32_bf16 v37, v48, s54, v37
    v_dot2_f32_bf16 v38, v52, s54, v38
    v_dot2_f32_bf16 v39, v56, s54, v39
    v_dot2_f32_bf16 v36, v45, s54, v36
    v_dot2_f32_bf16 v37, v49, s54, v37
    v_dot2_f32_bf16 v38, v53, s54, v38
    v_dot2_f32_bf16 v39, v57, s54, v39
    v_dot2_f32_bf16 v36, v46, s54, v36
    v_dot2_f32_bf16 v37, v50, s54, v37
    v_dot2_f32_bf16 v38, v54, s54, v38
    v_dot2_f32_bf16 v39, v58, s54, v39
    v_dot2_f32_bf16 v36, v47, s54, v36
    v_dot2_f32_bf16 v37, v51, s54, v37
    v_dot2_f32_bf16 v38, v55, s54, v38
    v_dot2_f32_bf16 v39, v59, s54, v39
    s_waitcnt vmcnt(16)
    ds_write_b128 v141, v[60:63] offset:0
    ds_write_b128 v141, v[64:67] offset:1152
    ds_write_b128 v141, v[68:71] offset:2304
    ds_write_b128 v141, v[72:75] offset:3456
    s_waitcnt lgkmcnt(0)
    ds_read_b64_tr_b16 v[60:61], v142 offset:0
    ds_read_b64_tr_b16 v[62:63], v142 offset:576
    ds_read_b64_tr_b16 v[64:65], v142 offset:32
    ds_read_b64_tr_b16 v[66:67], v142 offset:608
    ds_read_b64_tr_b16 v[68:69], v142 offset:64
    ds_read_b64_tr_b16 v[70:71], v142 offset:640
    ds_read_b64_tr_b16 v[72:73], v142 offset:96
    ds_read_b64_tr_b16 v[74:75], v142 offset:672
    s_waitcnt lgkmcnt(0)
    v_dot2_f32_bf16 v36, v60, s54, v36
    v_dot2_f32_bf16 v37, v64, s54, v37
    v_dot2_f32_bf16 v38, v68, s54, v38
    v_dot2_f32_bf16 v39, v72, s54, v39
    v_dot2_f32_bf16 v36, v61, s54, v36
    v_dot2_f32_bf16 v37, v65, s54, v37
    v_dot2_f32_bf16 v38, v69, s54, v38
    v_dot2_f32_bf16 v39, v73, s54, v39
    v_dot2_f32_bf16 v36, v62, s54, v36
    v_dot2_f32_bf16 v37, v66, s54, v37
    v_dot2_f32_bf16 v38, v70, s54, v38
    v_dot2_f32_bf16 v39, v74, s54, v39
    v_dot2_f32_bf16 v36, v63, s54, v36
    v_dot2_f32_bf16 v37, v67, s54, v37
    v_dot2_f32_bf16 v38, v71, s54, v38
    v_dot2_f32_bf16 v39, v75, s54, v39
    s_waitcnt vmcnt(12)
    ds_write_b128 v141, v[76:79] offset:0
    ds_write_b128 v141, v[80:83] offset:1152
    ds_write_b128 v141, v[84:87] offset:2304
    ds_write_b128 v141, v[88:91] offset:3456
    s_waitcnt lgkmcnt(0)
    ds_read_b64_tr_b16 v[76:77], v142 offset:0
    ds_read_b64_tr_b16 v[78:79], v142 offset:576
    ds_read_b64_tr_b16 v[80:81], v142 offset:32
    ds_read_b64_tr_b16 v[82:83], v142 offset:608
    ds_read_b64_tr_b16 v[84:85], v142 offset:64
    ds_read_b64_tr_b16 v[86:87], v142 offset:640
    ds_read_b64_tr_b16 v[88:89], v142 offset:96
    ds_read_b64_tr_b16 v[90:91], v142 offset:672
    s_waitcnt lgkmcnt(0)
    v_dot2_f32_bf16 v36, v76, s54, v36
    v_dot2_f32_bf16 v37, v80, s54, v37
    v_dot2_f32_bf16 v38, v84, s54, v38
    v_dot2_f32_bf16 v39, v88, s54, v39
    v_dot2_f32_bf16 v36, v77, s54, v36
    v_dot2_f32_bf16 v37, v81, s54, v37
    v_dot2_f32_bf16 v38, v85, s54, v38
    v_dot2_f32_bf16 v39, v89, s54, v39
    v_dot2_f32_bf16 v36, v78, s54, v36
    v_dot2_f32_bf16 v37, v82, s54, v37
    v_dot2_f32_bf16 v38, v86, s54, v38
    v_dot2_f32_bf16 v39, v90, s54, v39
    v_dot2_f32_bf16 v36, v79, s54, v36
    v_dot2_f32_bf16 v37, v83, s54, v37
    v_dot2_f32_bf16 v38, v87, s54, v38
    v_dot2_f32_bf16 v39, v91, s54, v39
    s_waitcnt vmcnt(8)
    ds_write_b128 v141, v[92:95] offset:0
    ds_write_b128 v141, v[96:99] offset:1152
    ds_write_b128 v141, v[100:103] offset:2304
    ds_write_b128 v141, v[104:107] offset:3456
    s_waitcnt lgkmcnt(0)
    ds_read_b64_tr_b16 v[92:93], v142 offset:0
    ds_read_b64_tr_b16 v[94:95], v142 offset:576
    ds_read_b64_tr_b16 v[96:97], v142 offset:32
    ds_read_b64_tr_b16 v[98:99], v142 offset:608
    ds_read_b64_tr_b16 v[100:101], v142 offset:64
    ds_read_b64_tr_b16 v[102:103], v142 offset:640
    ds_read_b64_tr_b16 v[104:105], v142 offset:96
    ds_read_b64_tr_b16 v[106:107], v142 offset:672
    s_waitcnt lgkmcnt(0)
    v_dot2_f32_bf16 v36, v92, s54, v36
    v_dot2_f32_bf16 v37, v96, s54, v37
    v_dot2_f32_bf16 v38, v100, s54, v38
    v_dot2_f32_bf16 v39, v104, s54, v39
    v_dot2_f32_bf16 v36, v93, s54, v36
    v_dot2_f32_bf16 v37, v97, s54, v37
    v_dot2_f32_bf16 v38, v101, s54, v38
    v_dot2_f32_bf16 v39, v105, s54, v39
    v_dot2_f32_bf16 v36, v94, s54, v36
    v_dot2_f32_bf16 v37, v98, s54, v37
    v_dot2_f32_bf16 v38, v102, s54, v38
    v_dot2_f32_bf16 v39, v106, s54, v39
    v_dot2_f32_bf16 v36, v95, s54, v36
    v_dot2_f32_bf16 v37, v99, s54, v37
    v_dot2_f32_bf16 v38, v103, s54, v38
    v_dot2_f32_bf16 v39, v107, s54, v39
    s_waitcnt vmcnt(4)
    ds_write_b128 v141, v[108:111] offset:0
    ds_write_b128 v141, v[112:115] offset:1152
    ds_write_b128 v141, v[116:119] offset:2304
    ds_write_b128 v141, v[120:123] offset:3456
    s_waitcnt lgkmcnt(0)
    ds_read_b64_tr_b16 v[108:109], v142 offset:0
    ds_read_b64_tr_b16 v[110:111], v142 offset:576
    ds_read_b64_tr_b16 v[112:113], v142 offset:32
    ds_read_b64_tr_b16 v[114:115], v142 offset:608
    ds_read_b64_tr_b16 v[116:117], v142 offset:64
    ds_read_b64_tr_b16 v[118:119], v142 offset:640
    ds_read_b64_tr_b16 v[120:121], v142 offset:96
    ds_read_b64_tr_b16 v[122:123], v142 offset:672
    s_waitcnt lgkmcnt(0)
    v_dot2_f32_bf16 v36, v108, s54, v36
    v_dot2_f32_bf16 v37, v112, s54, v37
    v_dot2_f32_bf16 v38, v116, s54, v38
    v_dot2_f32_bf16 v39, v120, s54, v39
    v_dot2_f32_bf16 v36, v109, s54, v36
    v_dot2_f32_bf16 v37, v113, s54, v37
    v_dot2_f32_bf16 v38, v117, s54, v38
    v_dot2_f32_bf16 v39, v121, s54, v39
    v_dot2_f32_bf16 v36, v110, s54, v36
    v_dot2_f32_bf16 v37, v114, s54, v37
    v_dot2_f32_bf16 v38, v118, s54, v38
    v_dot2_f32_bf16 v39, v122, s54, v39
    v_dot2_f32_bf16 v36, v111, s54, v36
    v_dot2_f32_bf16 v37, v115, s54, v37
    v_dot2_f32_bf16 v38, v119, s54, v38
    v_dot2_f32_bf16 v39, v123, s54, v39
    s_waitcnt vmcnt(0)
    ds_write_b128 v141, v[124:127] offset:0
    ds_write_b128 v141, v[128:131] offset:1152
    ds_write_b128 v141, v[132:135] offset:2304
    ds_write_b128 v141, v[136:139] offset:3456
    s_waitcnt lgkmcnt(0)
    ds_read_b64_tr_b16 v[124:125], v142 offset:0
    ds_read_b64_tr_b16 v[126:127], v142 offset:576
    ds_read_b64_tr_b16 v[128:129], v142 offset:32
    ds_read_b64_tr_b16 v[130:131], v142 offset:608
    ds_read_b64_tr_b16 v[132:133], v142 offset:64
    ds_read_b64_tr_b16 v[134:135], v142 offset:640
    ds_read_b64_tr_b16 v[136:137], v142 offset:96
    ds_read_b64_tr_b16 v[138:139], v142 offset:672
    s_waitcnt lgkmcnt(0)
    v_dot2_f32_bf16 v36, v124, s54, v36
    v_dot2_f32_bf16 v37, v128, s54, v37
    v_dot2_f32_bf16 v38, v132, s54, v38
    v_dot2_f32_bf16 v39, v136, s54, v39
    v_dot2_f32_bf16 v36, v125, s54, v36
    v_dot2_f32_bf16 v37, v129, s54, v37
    v_dot2_f32_bf16 v38, v133, s54, v38
    v_dot2_f32_bf16 v39, v137, s54, v39
    v_dot2_f32_bf16 v36, v126, s54, v36
    v_dot2_f32_bf16 v37, v130, s54, v37
    v_dot2_f32_bf16 v38, v134, s54, v38
    v_dot2_f32_bf16 v39, v138, s54, v39
    v_dot2_f32_bf16 v36, v127, s54, v36
    v_dot2_f32_bf16 v37, v131, s54, v37
    v_dot2_f32_bf16 v38, v135, s54, v38
    v_dot2_f32_bf16 v39, v139, s54, v39
    v_lshlrev_b32 v143, 4, v1
    buffer_store_dwordx4 v[44:47], v143, s[16:19], s44 offen sc1
    s_add_u32 s44, s44, s48
    buffer_store_dwordx4 v[48:51], v143, s[16:19], s45 offen sc1
    s_add_u32 s45, s45, s48
    buffer_store_dwordx4 v[52:55], v143, s[16:19], s46 offen sc1
    s_add_u32 s46, s46, s48
    buffer_store_dwordx4 v[56:59], v143, s[16:19], s47 offen sc1
    s_add_u32 s47, s47, s48
    buffer_store_dwordx4 v[60:63], v143, s[16:19], s44 offen sc1
    s_add_u32 s44, s44, s48
    buffer_store_dwordx4 v[64:67], v143, s[16:19], s45 offen sc1
    s_add_u32 s45, s45, s48
    buffer_store_dwordx4 v[68:71], v143, s[16:19], s46 offen sc1
    s_add_u32 s46, s46, s48
    buffer_store_dwordx4 v[72:75], v143, s[16:19], s47 offen sc1
    s_add_u32 s47, s47, s48
    buffer_store_dwordx4 v[76:79], v143, s[16:19], s44 offen sc1
    s_add_u32 s44, s44, s48
    buffer_store_dwordx4 v[80:83], v143, s[16:19], s45 offen sc1
    s_add_u32 s45, s45, s48
    buffer_store_dwordx4 v[84:87], v143, s[16:19], s46 offen sc1
    s_add_u32 s46, s46, s48
    buffer_store_dwordx4 v[88:91], v143, s[16:19], s47 offen sc1
    s_add_u32 s47, s47, s48
    buffer_store_dwordx4 v[92:95], v143, s[16:19], s44 offen sc1
    s_add_u32 s44, s44, s48
    buffer_store_dwordx4 v[96:99], v143, s[16:19], s45 offen sc1
    s_add_u32 s45, s45, s48
    buffer_store_dwordx4 v[100:103], v143, s[16:19], s46 offen sc1
    s_add_u32 s46, s46, s48
    buffer_store_dwordx4 v[104:107], v143, s[16:19], s47 offen sc1
    s_add_u32 s47, s47, s48
    buffer_store_dwordx4 v[108:111], v143, s[16:19], s44 offen sc1
    s_add_u32 s44, s44, s48
    buffer_store_dwordx4 v[112:115], v143, s[16:19], s45 offen sc1
    s_add_u32 s45, s45, s48
    buffer_store_dwordx4 v[116:119], v143, s[16:19], s46 offen sc1
    s_add_u32 s46, s46, s48
    buffer_store_dwordx4 v[120:123], v143, s[16:19], s47 offen sc1
    s_add_u32 s47, s47, s48
    buffer_store_dwordx4 v[124:127], v143, s[16:19], s44 offen sc1
    s_add_u32 s44, s44, s48
    buffer_store_dwordx4 v[128:131], v143, s[16:19], s45 offen sc1
    s_add_u32 s45, s45, s48
    buffer_store_dwordx4 v[132:135], v143, s[16:19], s46 offen sc1
    s_add_u32 s46, s46, s48
    buffer_store_dwordx4 v[136:139], v143, s[16:19], s47 offen sc1
    s_add_u32 s47, s47, s48
    s_cmp_eq_u32 s49, 0
    s_cbranch_scc1 Ljs_31
    v_mov_b32 v12, v36
    v_mov_b32 v13, v37
    v_mov_b32 v14, v38
    v_mov_b32 v15, v39
    v_permlane32_swap_b32 v36, v12
    v_permlane32_swap_b32 v37, v13
    v_permlane32_swap_b32 v38, v14
    v_permlane32_swap_b32 v39, v15
    v_add_f32 v36, v36, v12
    v_add_f32 v37, v37, v13
    v_add_f32 v38, v38, v14
    v_add_f32 v39, v39, v15
    v_mov_b32 v12, v36
    v_mov_b32 v13, v37
    v_mov_b32 v14, v38
    v_mov_b32 v15, v39
    v_permlane16_swap_b32 v36, v12
    v_permlane16_swap_b32 v37, v13
    v_permlane16_swap_b32 v38, v14
    v_permlane16_swap_b32 v39, v15
    v_add_f32 v36, v36, v12
    v_add_f32 v37, v37, v13
    v_add_f32 v38, v38, v14
    v_add_f32 v39, v39, v15
    v_lshlrev_b32 v12, 2, v1
    s_mov_b64 exec, s[64:65]
    buffer_store_dword v36, v12, s[16:19], s49 offen offset:0 sc1
    buffer_store_dword v37, v12, s[16:19], s49 offen offset:64 sc1
    buffer_store_dword v38, v12, s[16:19], s49 offen offset:128 sc1
    buffer_store_dword v39, v12, s[16:19], s49 offen offset:192 sc1
    s_mov_b64 exec, -1
Ljs_31:
L_p2b_c:
    s_barrier
    s_cmp_ge_u32 s3, 9
    s_cbranch_scc1 Lcs9_32
    v_lshlrev_b32 v12, 4, v0
    v_add_u32 v13, 46080, v12
    ds_read_b128 v[16:19], v13
    s_mul_i32 s31, s62, 589824
    s_mul_i32 s32, s61, 9216
    s_add_u32 s31, s31, s32
    s_add_u32 s31, s31, 0x580000
    s_waitcnt lgkmcnt(0)
    buffer_store_dwordx4 v[16:19], v12, s[16:19], s31 offen sc1
    s_branch Lcsd_33
Lcs9_32:
Lcsd_33:
    s_waitcnt vmcnt(0)
    s_barrier
    s_cmp_eq_u32 s3, 11
    s_cbranch_scc0 L_p2b_f
    s_lshl_b32 s31, s63, 7
    s_mov_b64 exec, 1
    v_mov_b32 v12, s28
    v_mov_b32 v13, 0x18000
    buffer_store_dword v12, v13, s[16:19], s31 offen sc1
    s_mov_b64 exec, -1
L_p2b_f:
    s_cmp_ge_u32 s3, 9
    s_cbranch_scc1 L_p3_nw
    s_mul_i32 s31, s62, 9
    s_add_u32 s31, s31, s3
    s_mul_i32 s31, s31, 18432
    s_add_u32 s31, s31, 0xb46400
    buffer_load_dwordx4 v[132:135], v3, s[16:19], s31 offen offset:0 sc1
    buffer_load_dwordx4 v[136:139], v3, s[16:19], s31 offen offset:1024 sc1
    buffer_load_dwordx4 v[140:143], v3, s[16:19], s31 offen offset:2048 sc1
    buffer_load_dwordx4 v[144:147], v3, s[16:19], s31 offen offset:3072 sc1
    s_add_u32 s31, s31, 4096
    buffer_load_dwordx4 v[148:151], v3, s[16:19], s31 offen offset:0 sc1
    buffer_load_dwordx4 v[152:155], v3, s[16:19], s31 offen offset:1024 sc1
    buffer_load_dwordx4 v[156:159], v3, s[16:19], s31 offen offset:2048 sc1
    buffer_load_dwordx4 v[160:163], v3, s[16:19], s31 offen offset:3072 sc1
    s_add_u32 s31, s31, 4096
    buffer_load_dwordx4 v[164:167], v3, s[16:19], s31 offen offset:0 sc1
L_p3_nw:
    s_cmp_eq_u32 s3, 11
    s_cbranch_scc0 L_p3_np
    s_lshl_b32 s31, s61, 2
    s_sub_u32 s31, s31, 4
    v_add_u32 v12, s31, v1
    v_max_i32 v12, 0, v12
    v_min_i32 v12, 255, v12
    v_lshlrev_b32 v12, 7, v12
    v_add_u32 v12, 0x18000, v12
    s_mov_b32 exec_lo, 0xfff
    s_mov_b32 exec_hi, 0x0
    s_mov_b32 s72, 0x40000
Lpoll_34:
    buffer_load_dword v13, v12, s[16:19], 0 offen sc1
    s_waitcnt vmcnt(0)
    v_cmp_ne_u32 vcc, s28, v13
    s_cbranch_vccz Lpolld_35
    s_sub_u32 s72, s72, 1
    s_cbranch_scc1 Lpolld_35
    s_sleep 2
    s_branch Lpoll_34
Lpolld_35:
    s_mov_b64 exec, -1
L_p3_np:
    s_barrier
    s_cmp_ge_u32 s3, 9
    s_cbranch_scc1 L_p3_b
    s_lshl_b32 s31, s3, 6
    v_add_u32 v12, s31, v1
    v_mul_u32_u24 v13, 911, v12
    v_lshrrev_b32 v13, 16, v13
    v_mul_u32_u24 v14, 72, v13
    v_sub_u32 v14, v12, v14
    v_xor_b32 v14, v14, v13
    v_mul_u32_u24 v15, 57, v14
    v_lshrrev_b32 v15, 10, v15
    v_lshrrev_b32 v16, 1, v15
    v_add_u32 v16, 1, v16
    v_and_b32 v17, 1, v15
    v_cmp_eq_u32 vcc, 1, v17
    v_sub_u32 v17, 0, v16
    s_nop 0
    v_cndmask_b32 v16, v17, v16, vcc
    v_add_u32 v13, v13, v16
    s_lshl_b32 s32, s61, 5
    v_add_u32 v13, s32, v13
    v_add_u32 v16, 2, v16
    v_mul_u32_u24 v16, 288, v16
    v_add_u32 v16, v4, v16
    s_mul_i32 s33, s61, 9216
    s_add_u32 s33, s33, 0x57fdc0
    s_lshl_b32 s31, s3, 10
    v_mov_b32 v18, 0x7fffffff
    v_cmp_gt_u32 vcc, 2048, v13
    s_nop 1
    v_cndmask_b32 v17, v18, v16, vcc
    s_mov_b32 m0, s31
    s_add_u32 s31, s31, 9216
    buffer_load_dwordx4 v17, s[16:19], s33 offen sc1 lds
    s_add_u32 s33, s33, 2304
    v_add_u32 v13, 8, v13
    v_cmp_gt_u32 vcc, 2048, v13
    s_nop 1
    v_cndmask_b32 v17, v18, v16, vcc
    s_mov_b32 m0, s31
    s_add_u32 s31, s31, 9216
    buffer_load_dwordx4 v17, s[16:19], s33 offen sc1 lds
    s_add_u32 s33, s33, 2304
    v_add_u32 v13, 8, v13
    v_cmp_gt_u32 vcc, 2048, v13
    s_nop 1
    v_cndmask_b32 v17, v18, v16, vcc
    s_mov_b32 m0, s31
    s_add_u32 s31, s31, 9216
    buffer_load_dwordx4 v17, s[16:19], s33 offen sc1 lds
    s_add_u32 s33, s33, 2304
    v_add_u32 v13, 8, v13
    v_cmp_gt_u32 vcc, 2048, v13
    s_nop 1
    v_cndmask_b32 v17, v18, v16, vcc
    s_mov_b32 m0, s31
    s_add_u32 s31, s31, 9216
    buffer_load_dwordx4 v17, s[16:19], s33 offen sc1 lds
    s_add_u32 s33, s33, 2304
    v_add_u32 v13, 8, v13
    s_waitcnt vmcnt(0)
L_p3_b:
    s_barrier
    s_cmp_ge_u32 s3, 9
    s_cbranch_scc1 L_p3_h
    v_and_b32 v12, 15, v1
    v_lshrrev_b32 v13, 4, v1
    v_and_b32 v14, 7, v12
    v_mul_u32_u24 v15, 1152, v12
    v_xor_b32 v16, v13, v14
    v_lshl_add_u32 v8, v16, 4, v15
    v_or_b32 v16, 4, v13
    v_xor_b32 v16, v16, v14
    v_lshl_add_u32 v9, v16, 4, v15
    ds_read_b128 v[20:23], v8 offset:0
    ds_read_b128 v[24:27], v8 offset:18432
    ds_read_b128 v[28:31], v9 offset:0
    ds_read_b128 v[32:35], v9 offset:18432
    ds_read_b128 v[36:39], v8 offset:128
    ds_read_b128 v[40:43], v8 offset:18560
    ds_read_b128 v[44:47], v9 offset:128
    ds_read_b128 v[48:51], v9 offset:18560
    s_waitcnt lgkmcnt(6)
    v_mfma_f32_16x16x32_bf16 v[52:55], v[96:99], v[20:23], 0
    v_mfma_f32_16x16x32_bf16 v[56:59], v[96:99], v[24:27], 0
    ds_read_b128 v[20:23], v8 offset:256
    ds_read_b128 v[24:27], v8 offset:18688
    s_waitcnt lgkmcnt(6)
    v_mfma_f32_16x16x32_bf16 v[52:55], v[100:103], v[28:31], v[52:55]
    v_mfma_f32_16x16x32_bf16 v[56:59], v[100:103], v[32:35], v[56:59]
    ds_read_b128 v[28:31], v9 offset:256
    ds_read_b128 v[32:35], v9 offset:18688
    s_waitcnt lgkmcnt(6)
    v_mfma_f32_16x16x32_bf16 v[52:55], v[104:107], v[36:39], v[52:55]
    v_mfma_f32_16x16x32_bf16 v[56:59], v[104:107], v[40:43], v[56:59]
    ds_read_b128 v[36:39], v8 offset:384
    ds_read_b128 v[40:43], v8 offset:18816
    s_waitcnt lgkmcnt(6)
    v_mfma_f32_16x16x32_bf16 v[52:55], v[108:111], v[44:47], v[52:55]
    v_mfma_f32_16x16x32_bf16 v[56:59], v[108:111], v[48:51], v[56:59]
    ds_read_b128 v[44:47], v9 offset:384
    ds_read_b128 v[48:51], v9 offset:18816
    s_waitcnt lgkmcnt(6)
    v_mfma_f32_16x16x32_bf16 v[52:55], v[112:115], v[20:23], v[52:55]
    v_mfma_f32_16x16x32_bf16 v[56:59], v[112:115], v[24:27], v[56:59]
    ds_read_b128 v[20:23], v8 offset:512
    ds_read_b128 v[24:27], v8 offset:18944
    s_waitcnt lgkmcnt(6)
    v_mfma_f32_16x16x32_bf16 v[52:55], v[116:119], v[28:31], v[52:55]
    v_mfma_f32_16x16x32_bf16 v[56:59], v[116:119], v[32:35], v[56:59]
    ds_read_b128 v[28:31], v9 offset:512
    ds_read_b128 v[32:35], v9 offset:18944
    s_waitcnt lgkmcnt(6)
    v_mfma_f32_16x16x32_bf16 v[52:55], v[120:123], v[36:39], v[52:55]
    v_mfma_f32_16x16x32_bf16 v[56:59], v[120:123], v[40:43], v[56:59]
    ds_read_b128 v[36:39], v8 offset:640
    ds_read_b128 v[40:43], v8 offset:19072
    s_waitcnt lgkmcnt(6)
    v_mfma_f32_16x16x32_bf16 v[52:55], v[124:127], v[44:47], v[52:55]
    v_mfma_f32_16x16x32_bf16 v[56:59], v[124:127], v[48:51], v[56:59]
    ds_read_b128 v[44:47], v9 offset:640
    ds_read_b128 v[48:51], v9 offset:19072
    s_waitcnt lgkmcnt(6)
    v_mfma_f32_16x16x32_bf16 v[52:55], v[128:131], v[20:23], v[52:55]
    v_mfma_f32_16x16x32_bf16 v[56:59], v[128:131], v[24:27], v[56:59]
    ds_read_b128 v[20:23], v8 offset:768
    ds_read_b128 v[24:27], v8 offset:19200
    s_waitcnt lgkmcnt(6)
    v_mfma_f32_16x16x32_bf16 v[52:55], v[132:135], v[28:31], v[52:55]
    v_mfma_f32_16x16x32_bf16 v[56:59], v[132:135], v[32:35], v[56:59]
    ds_read_b128 v[28:31], v9 offset:768
    ds_read_b128 v[32:35], v9 offset:19200
    s_waitcnt lgkmcnt(6)
    v_mfma_f32_16x16x32_bf16 v[52:55], v[136:139], v[36:39], v[52:55]
    v_mfma_f32_16x16x32_bf16 v[56:59], v[136:139], v[40:43], v[56:59]
    ds_read_b128 v[36:39], v8 offset:896
    ds_read_b128 v[40:43], v8 offset:19328
    s_waitcnt lgkmcnt(6)
    v_mfma_f32_16x16x32_bf16 v[52:55], v[140:143], v[44:47], v[52:55]
    v_mfma_f32_16x16x32_bf16 v[56:59], v[140:143], v[48:51], v[56:59]
    ds_read_b128 v[44:47], v9 offset:896
    ds_read_b128 v[48:51], v9 offset:19328
    s_waitcnt lgkmcnt(6)
    v_mfma_f32_16x16x32_bf16 v[52:55], v[144:147], v[20:23], v[52:55]
    v_mfma_f32_16x16x32_bf16 v[56:59], v[144:147], v[24:27], v[56:59]
    ds_read_b128 v[20:23], v8 offset:1024
    ds_read_b128 v[24:27], v8 offset:19456
    s_waitcnt lgkmcnt(6)
    v_mfma_f32_16x16x32_bf16 v[52:55], v[148:151], v[28:31], v[52:55]
    v_mfma_f32_16x16x32_bf16 v[56:59], v[148:151], v[32:35], v[56:59]
    ds_read_b128 v[28:31], v9 offset:1024
    ds_read_b128 v[32:35], v9 offset:19456
    s_waitcnt lgkmcnt(6)
    v_mfma_f32_16x16x32_bf16 v[52:55], v[152:155], v[36:39], v[52:55]
    v_mfma_f32_16x16x32_bf16 v[56:59], v[152:155], v[40:43], v[56:59]
    s_waitcnt lgkmcnt(4)
    v_mfma_f32_16x16x32_bf16 v[52:55], v[156:159], v[44:47], v[52:55]
    v_mfma_f32_16x16x32_bf16 v[56:59], v[156:159], v[48:51], v[56:59]
    s_waitcnt lgkmcnt(2)
    v_mfma_f32_16x16x32_bf16 v[52:55], v[160:163], v[20:23], v[52:55]
    v_mfma_f32_16x16x32_bf16 v[56:59], v[160:163], v[24:27], v[56:59]
    s_waitcnt lgkmcnt(0)
    v_mfma_f32_16x16x32_bf16 v[52:55], v[164:167], v[28:31], v[52:55]
    v_mfma_f32_16x16x32_bf16 v[56:59], v[164:167], v[32:35], v[56:59]
    s_mov_b32 s52, 0x3f803f80
    ds_read_b64 v[60:61], v5 offset:36864
    ds_read_b64 v[62:63], v5 offset:41472
    v_and_b32 v12, 15, v1
    v_lshlrev_b32 v12, 4, v12
    ds_read_b128 v[64:67], v12 offset:57600
    ds_read_b128 v[68:71], v12 offset:57856
    s_waitcnt lgkmcnt(0)
    v_lshlrev_b32 v12, 16, v60
    v_and_b32 v13, 0xffff0000, v60
    v_lshlrev_b32 v14, 16, v61
    v_and_b32 v15, 0xffff0000, v61
    v_sub_f32 v12, v12, v64
    v_sub_f32 v13, v13, v64
    v_sub_f32 v14, v14, v64
    v_sub_f32 v15, v15, v64
    v_fma_f32 v52, v12, v66, v52
    v_fma_f32 v53, v13, v66, v53
    v_fma_f32 v54, v14, v66, v54
    v_fma_f32 v55, v15, v66, v55
    v_cvt_pk_bf16_f32 v60, v52, v53
    v_cvt_pk_bf16_f32 v61, v54, v55
    ds_write_b64 v5, v[60:61] offset:46080
    v_lshlrev_b32 v12, 16, v62
    v_and_b32 v13, 0xffff0000, v62
    v_lshlrev_b32 v14, 16, v63
    v_and_b32 v15, 0xffff0000, v63
    v_sub_f32 v12, v12, v68
    v_sub_f32 v13, v13, v68
    v_sub_f32 v14, v14, v68
    v_sub_f32 v15, v15, v68
    v_fma_f32 v56, v12, v70, v56
    v_fma_f32 v57, v13, v70, v57
    v_fma_f32 v58, v14, v70, v58
    v_fma_f32 v59, v15, v70, v59
    v_cvt_pk_bf16_f32 v62, v56, v57
    v_cvt_pk_bf16_f32 v63, v58, v59
    ds_write_b64 v5, v[62:63] offset:50688
    v_mov_b32 v20, 0
    v_mov_b32 v21, 0
    v_dot2_f32_bf16 v20, v60, s52, v20
    v_dot2_f32_bf16 v21, v60, v60, v21
    v_dot2_f32_bf16 v20, v61, s52, v20
    v_dot2_f32_bf16 v21, v61, v61, v21
    v_mov_b32 v22, 0
    v_mov_b32 v23, 0
    v_dot2_f32_bf16 v22, v62, s52, v22
    v_dot2_f32_bf16 v23, v62, v62, v23
    v_dot2_f32_bf16 v22, v63, s52, v22
    v_dot2_f32_bf16 v23, v63, v63, v23
    v_mov_b32 v24, v20
    v_mov_b32 v25, v21
    v_mov_b32 v26, v22
    v_mov_b32 v27, v23
    v_permlane32_swap_b32 v20, v24
    v_permlane32_swap_b32 v21, v25
    v_permlane32_swap_b32 v22, v26
    v_permlane32_swap_b32 v23, v27
    v_add_f32 v20, v20, v24
    v_add_f32 v21, v21, v25
    v_add_f32 v22, v22, v26
    v_add_f32 v23, v23, v27
    v_mov_b32 v24, v20
    v_mov_b32 v25, v21
    v_mov_b32 v26, v22
    v_mov_b32 v27, v23
    v_permlane16_swap_b32 v20, v24
    v_permlane16_swap_b32 v21, v25
    v_permlane16_swap_b32 v22, v26
    v_permlane16_swap_b32 v23, v27
    v_add_f32 v20, v20, v24
    v_add_f32 v21, v21, v25
    v_add_f32 v22, v22, v26
    v_add_f32 v23, v23, v27
    s_mov_b64 exec, s[64:65]
    ds_write_b64 v6, v[20:21] offset:0
    ds_write_b64 v6, v[22:23] offset:128
    s_mov_b64 exec, -1
    s_waitcnt lgkmcnt(0)
    s_branch L_p3_c
L_p3_h:
    s_cmp_eq_u32 s3, 9
    s_cbranch_scc1 L_p3_c
    s_cmp_eq_u32 s3, 10
    s_cbranch_scc1 L_p3_h4
    s_cmp_eq_u32 s73, 1
    s_cbranch_scc0 L_p3_c
    s_waitcnt vmcnt(0)
    s_lshl_b32 s31, s29, 7
    s_mov_b64 exec, 1
    v_mov_b32 v12, 1
    v_mov_b32 v13, 0x3cc00
    buffer_atomic_add v12, v13, s[16:19], s31 offen sc0 sc1
    s_waitcnt vmcnt(0)
    v_readfirstlane_b32 s72, v12
    s_mov_b64 exec, -1
    s_cmp_eq_u32 s72, 26
    s_cbranch_scc0 Larr_36
    s_mov_b64 exec, 0x1
    v_lshlrev_b32 v13, 7, v1
    v_add_u32 v13, 0x3f400, v13
    v_mov_b32 v12, s28
    buffer_store_dword v12, v13, s[16:19], s31 offen sc1
    s_mov_b64 exec, -1
Larr_36:
    s_branch L_p3_c
L_p3_h4:
L_p3_c:
    s_barrier
    s_cmp_ge_u32 s3, 9
    s_cbranch_scc1 Lcs9_37
    v_lshlrev_b32 v12, 4, v0
    v_add_u32 v13, 46080, v12
    ds_read_b128 v[16:19], v13
    s_mul_i32 s31, s62, 589824
    s_mul_i32 s32, s61, 9216
    s_add_u32 s31, s31, s32
    s_add_u32 s31, s31, 0x7c0000
    s_waitcnt lgkmcnt(0)
    buffer_store_dwordx4 v[16:19], v12, s[16:19], s31 offen sc1
    s_branch Lcsd_38
Lcs9_37:
    s_cmp_eq_u32 s3, 9
    s_cbranch_scc0 Lcsd_38
    s_mov_b32 exec_lo, -1
    s_mov_b32 exec_hi, 0
    v_lshlrev_b32 v12, 3, v1
    v_add_u32 v13, 55296, v12
    ds_read_b64 v[20:21], v13 offset:0
    ds_read_b64 v[22:23], v13 offset:256
    ds_read_b64 v[24:25], v13 offset:512
    ds_read_b64 v[26:27], v13 offset:768
    ds_read_b64 v[28:29], v13 offset:1024
    ds_read_b64 v[30:31], v13 offset:1280
    ds_read_b64 v[32:33], v13 offset:1536
    ds_read_b64 v[34:35], v13 offset:1792
    ds_read_b64 v[36:37], v13 offset:2048
    s_lshl_b32 s31, s63, 8
    s_add_u32 s31, s31, 0x50000
    s_waitcnt lgkmcnt(0)
    v_pk_add_f32 v[20:21], v[20:21], v[22:23]
    v_pk_add_f32 v[20:21], v[20:21], v[24:25]
    v_pk_add_f32 v[20:21], v[20:21], v[26:27]
    v_pk_add_f32 v[20:21], v[20:21], v[28:29]
    v_pk_add_f32 v[20:21], v[20:21], v[30:31]
    v_pk_add_f32 v[20:21], v[20:21], v[32:33]
    v_pk_add_f32 v[20:21], v[20:21], v[34:35]
    v_pk_add_f32 v[20:21], v[20:21], v[36:37]
    buffer_store_dwordx2 v[20:21], v12, s[16:19], s31 offen sc1
    s_mov_b64 exec, -1
Lcsd_38:
    s_waitcnt vmcnt(0)
    s_barrier
    s_cmp_eq_u32 s3, 11
    s_cbranch_scc0 L_p3_f
    s_lshl_b32 s31, s63, 7
    s_mov_b64 exec, 1
    v_mov_b32 v12, s28
    v_mov_b32 v13, 0x20000
    buffer_store_dword v12, v13, s[16:19], s31 offen sc1
    s_mov_b64 exec, -1
L_p3_f:
    s_and_b32 s61, s29, 3
    s_lshl_b32 s61, s61, 1
    s_and_b32 s31, s30, 1
    s_add_u32 s61, s61, s31
    s_lshr_b32 s62, s29, 2
    s_lshl_b32 s62, s62, 4
    s_lshr_b32 s31, s30, 1
    s_add_u32 s62, s62, s31
    v_lshlrev_b32 v3, 4, v1
    s_mul_i32 s45, s61, 12
    s_add_u32 s45, s45, s3
    s_mul_i32 s45, s45, 55296
    s_add_u32 s45, s45, 0xc00000
    s_lshl_b32 s31, s3, 6
    v_add_u32 v12, s31, v1
    v_mul_u32_u24 v13, 911, v12
    v_lshrrev_b32 v13, 16, v13
    v_mul_u32_u24 v14, 72, v13
    v_sub_u32 v14, v12, v14
    v_xor_b32 v14, v14, v13
    v_mul_u32_u24 v15, 57, v14
    v_lshrrev_b32 v15, 10, v15
    v_mul_u32_u24 v16, 18, v15
    v_sub_u32 v16, v14, v16
    v_mul_u32_u24 v13, 288, v13
    v_lshl_add_u32 v13, v16, 4, v13
    s_mov_b32 s31, 589824
    v_mul_lo_u32 v15, v15, s31
    v_add_u32 v4, v13, v15
    v_and_b32 v12, 15, v1
    v_lshrrev_b32 v13, 4, v1
    v_and_b32 v14, 7, v12
    v_mul_u32_u24 v15, 1152, v12
    v_xor_b32 v16, v13, v14
    v_lshl_add_u32 v8, v16, 4, v15
    v_or_b32 v16, 4, v13
    v_xor_b32 v16, v16, v14
    v_lshl_add_u32 v9, v16, 4, v15
    s_cmp_eq_u32 s3, 9
    s_cbranch_scc0 L_m_nc
    s_mul_i32 s31, s61, 2304
    s_add_u32 s31, s31, 0x62000
    buffer_load_dwordx4 v[52:55], v3, s[16:19], s31 offen offset:0 sc1
    buffer_load_dwordx4 v[56:59], v3, s[16:19], s31 offen offset:1024 sc1
    s_mov_b64 exec, 0xffff
    buffer_load_dwordx4 v[60:63], v3, s[16:19], s31 offen offset:2048 sc1
    s_mov_b64 exec, -1
    s_add_u32 s31, s31, 18432
    buffer_load_dwordx4 v[64:67], v3, s[16:19], s31 offen offset:0 sc1
    buffer_load_dwordx4 v[68:71], v3, s[16:19], s31 offen offset:1024 sc1
    s_mov_b64 exec, 0xffff
    buffer_load_dwordx4 v[72:75], v3, s[16:19], s31 offen offset:2048 sc1
    s_mov_b64 exec, -1
    s_add_u32 s31, s31, 18432
    buffer_load_dwordx4 v[76:79], v3, s[16:19], s31 offen offset:0 sc1
    buffer_load_dwordx4 v[80:83], v3, s[16:19], s31 offen offset:1024 sc1
    s_mov_b64 exec, 0xffff
    buffer_load_dwordx4 v[84:87], v3, s[16:19], s31 offen offset:2048 sc1
    s_mov_b64 exec, -1
L_m_nc:
    buffer_load_dwordx4 v[100:103], v3, s[16:19], s45 offen offset:0 sc1
    buffer_load_dwordx4 v[104:107], v3, s[16:19], s45 offen offset:1024 sc1
    buffer_load_dwordx4 v[108:111], v3, s[16:19], s45 offen offset:2048 sc1
    s_add_u32 s45, s45, 3072
    buffer_load_dwordx4 v[112:115], v3, s[16:19], s45 offen offset:0 sc1
    buffer_load_dwordx4 v[116:119], v3, s[16:19], s45 offen offset:1024 sc1
    buffer_load_dwordx4 v[120:123], v3, s[16:19], s45 offen offset:2048 sc1
    s_add_u32 s45, s45, 3072
    s_cmp_eq_u32 s3, 11
    s_cbranch_scc0 L_m_np
    s_lshl_b32 s31, s62, 10
    s_add_u32 s31, s31, 0x20000
    v_lshlrev_b32 v12, 7, v1
    v_add_u32 v12, s31, v12
    s_mov_b32 exec_lo, 0xff
    s_mov_b32 exec_hi, 0x0
    s_mov_b32 s72, 0x40000
Lpoll_39:
    buffer_load_dword v13, v12, s[16:19], 0 offen sc1
    s_waitcnt vmcnt(0)
    v_cmp_ne_u32 vcc, s28, v13
    s_cbranch_vccz Lpolld_40
    s_sub_u32 s72, s72, 1
    s_cbranch_scc1 Lpolld_40
    s_sleep 2
    s_branch Lpoll_39
Lpolld_40:
    s_mov_b64 exec, -1
L_m_np:
    s_barrier
    s_cmp_ge_u32 s3, 9
    s_cbranch_scc1 L_m_nd
    s_mul_i32 s33, s62, 18432
    s_add_u32 s33, s33, 0x7c0000
    s_lshl_b32 s31, s3, 10
    s_mov_b32 m0, s31
    s_add_u32 s31, s31, 9216
    buffer_load_dwordx4 v4, s[16:19], s33 offen sc1 lds
    s_add_u32 s33, s33, 2304
    s_mov_b32 m0, s31
    s_add_u32 s31, s31, 9216
    buffer_load_dwordx4 v4, s[16:19], s33 offen sc1 lds
    s_add_u32 s33, s33, 2304
    s_mov_b32 m0, s31
    s_add_u32 s31, s31, 9216
    buffer_load_dwordx4 v4, s[16:19], s33 offen sc1 lds
    s_add_u32 s33, s33, 2304
    s_mov_b32 m0, s31
    s_add_u32 s31, s31, 9216
    buffer_load_dwordx4 v4, s[16:19], s33 offen sc1 lds
    s_add_u32 s33, s33, 2304
    s_mov_b32 m0, s31
    s_add_u32 s31, s31, 9216
    buffer_load_dwordx4 v4, s[16:19], s33 offen sc1 lds
    s_add_u32 s33, s33, 2304
    s_mov_b32 m0, s31
    s_add_u32 s31, s31, 9216
    buffer_load_dwordx4 v4, s[16:19], s33 offen sc1 lds
    s_add_u32 s33, s33, 2304
    s_mov_b32 m0, s31
    s_add_u32 s31, s31, 9216
    buffer_load_dwordx4 v4, s[16:19], s33 offen sc1 lds
    s_add_u32 s33, s33, 2304
    s_mov_b32 m0, s31
    s_add_u32 s31, s31, 9216
    buffer_load_dwordx4 v4, s[16:19], s33 offen sc1 lds
    s_add_u32 s33, s33, 2304
L_m_nd:
    s_cmp_eq_u32 s3, 11
    s_cbranch_scc0 L_m_ns
    v_lshrrev_b32 v12, 5, v1
    v_lshlrev_b32 v12, 10, v12
    v_and_b32 v13, 31, v1
    v_lshl_add_u32 v12, v13, 3, v12
    s_lshl_b32 s31, s62, 11
    s_add_u32 s31, s31, 0x50000
    buffer_load_dwordx2 v[88:89], v12, s[16:19], s31 offen offset:0 sc1
    buffer_load_dwordx2 v[90:91], v12, s[16:19], s31 offen offset:256 sc1
    buffer_load_dwordx2 v[92:93], v12, s[16:19], s31 offen offset:512 sc1
    buffer_load_dwordx2 v[94:95], v12, s[16:19], s31 offen offset:768 sc1
L_m_ns:
    s_cmp_eq_u32 s3, 10
    s_cbranch_scc0 L_m_n10
    s_and_b32 s31, s29, 3
    s_lshl_b32 s31, s31, 8
    s_add_u32 s31, s31, 0x3f400
    v_lshlrev_b32 v12, 7, v1
    v_add_u32 v12, s31, v12
    s_mov_b32 exec_lo, 0x3
    s_mov_b32 exec_hi, 0x0
    s_mov_b32 s72, 0x40000
Lpoll_41:
    buffer_load_dword v13, v12, s[16:19], 0 offen sc1
    s_waitcnt vmcnt(0)
    v_cmp_ne_u32 vcc, s28, v13
    s_cbranch_vccz Lpolld_42
    s_sub_u32 s72, s72, 1
    s_cbranch_scc1 Lpolld_42
    s_sleep 2
    s_branch Lpoll_41
Lpolld_42:
    s_mov_b64 exec, -1
L_m_n10:
    s_barrier
    buffer_load_dwordx4 v[124:127], v3, s[16:19], s45 offen offset:0 sc1
    buffer_load_dwordx4 v[128:131], v3, s[16:19], s45 offen offset:1024 sc1
    buffer_load_dwordx4 v[132:135], v3, s[16:19], s45 offen offset:2048 sc1
    s_add_u32 s45, s45, 3072
    buffer_load_dwordx4 v[136:139], v3, s[16:19], s45 offen offset:0 sc1
    buffer_load_dwordx4 v[140:143], v3, s[16:19], s45 offen offset:1024 sc1
    buffer_load_dwordx4 v[144:147], v3, s[16:19], s45 offen offset:2048 sc1
    s_add_u32 s45, s45, 3072
    s_waitcnt vmcnt(6)
    s_cmp_eq_u32 s3, 9
    s_cbranch_scc0 L_m_nc2
    v_pk_add_f32 v[52:53], v[52:53], v[64:65]
    v_pk_add_f32 v[52:53], v[52:53], v[76:77]
    v_pk_add_f32 v[54:55], v[54:55], v[66:67]
    v_pk_add_f32 v[54:55], v[54:55], v[78:79]
    v_pk_add_f32 v[56:57], v[56:57], v[68:69]
    v_pk_add_f32 v[56:57], v[56:57], v[80:81]
    v_pk_add_f32 v[58:59], v[58:59], v[70:71]
    v_pk_add_f32 v[58:59], v[58:59], v[82:83]
    v_pk_add_f32 v[60:61], v[60:61], v[72:73]
    v_pk_add_f32 v[60:61], v[60:61], v[84:85]
    v_pk_add_f32 v[62:63], v[62:63], v[74:75]
    v_pk_add_f32 v[62:63], v[62:63], v[86:87]
    v_add_u32 v12, 148480, v3
    ds_write_b128 v12, v[52:55]
    ds_write_b128 v12, v[56:59] offset:1024
    s_mov_b64 exec, 0xffff
    ds_write_b128 v12, v[60:63] offset:2048
    s_mov_b64 exec, -1
L_m_nc2:
    s_cmp_eq_u32 s3, 11
    s_cbranch_scc0 L_m_ns2
    v_add_f32 v88, v88, v90
    v_add_f32 v89, v89, v91
    v_add_f32 v92, v92, v94
    v_add_f32 v93, v93, v95
    v_add_f32 v88, v88, v92
    v_add_f32 v89, v89, v93
    v_mul_f32 v88, 0x3ae38e39, v88
    v_mul_f32 v89, 0x3ae38e39, v89
    v_fma_f32 v89, -v88, v88, v89
    v_max_f32 v89, 0, v89
    v_add_f32 v89, 0x3727c5ac, v89
    v_rsq_f32 v90, v89
    s_nop 0
    v_mul_f32 v91, v88, v90
    v_lshlrev_b32 v12, 3, v1
    v_add_u32 v12, 147456, v12
    ds_write_b64 v12, v[90:91]
L_m_ns2:
    v_mov_b32 v52, 0
    v_mov_b32 v53, 0
    v_mov_b32 v54, 0
    v_mov_b32 v55, 0
    v_mov_b32 v56, 0
    v_mov_b32 v57, 0
    v_mov_b32 v58, 0
    v_mov_b32 v59, 0
    v_mov_b32 v60, 0
    v_mov_b32 v61, 0
    v_mov_b32 v62, 0
    v_mov_b32 v63, 0
    v_mov_b32 v64, 0
    v_mov_b32 v65, 0
    v_mov_b32 v66, 0
    v_mov_b32 v67, 0
    v_mov_b32 v68, 0
    v_mov_b32 v69, 0
    v_mov_b32 v70, 0
    v_mov_b32 v71, 0
    v_mov_b32 v72, 0
    v_mov_b32 v73, 0
    v_mov_b32 v74, 0
    v_mov_b32 v75, 0
    v_mov_b32 v76, 0
    v_mov_b32 v77, 0
    v_mov_b32 v78, 0
    v_mov_b32 v79, 0
    v_mov_b32 v80, 0
    v_mov_b32 v81, 0
    v_mov_b32 v82, 0
    v_mov_b32 v83, 0
    v_mov_b32 v84, 0
    v_mov_b32 v85, 0
    v_mov_b32 v86, 0
    v_mov_b32 v87, 0
    v_mov_b32 v88, 0
    v_mov_b32 v89, 0
    v_mov_b32 v90, 0
    v_mov_b32 v91, 0
    v_mov_b32 v92, 0
    v_mov_b32 v93, 0
    v_mov_b32 v94, 0
    v_mov_b32 v95, 0
    v_mov_b32 v96, 0
    v_mov_b32 v97, 0
    v_mov_b32 v98, 0
    v_mov_b32 v99, 0
    s_waitcnt lgkmcnt(0)
    s_barrier
    ds_read_b128 v[20:23], v8 offset:0
    ds_read_b128 v[24:27], v8 offset:18432
    ds_read_b128 v[28:31], v8 offset:36864
    ds_read_b128 v[32:35], v8 offset:55296
    s_waitcnt vmcnt(9) lgkmcnt(0)
    v_mfma_f32_16x16x32_bf16 v[52:55], v[100:103], v[20:23], v[52:55]
    ds_read_b128 v[36:39], v9 offset:0
    v_mfma_f32_16x16x32_bf16 v[68:71], v[104:107], v[20:23], v[68:71]
    v_mfma_f32_16x16x32_bf16 v[84:87], v[108:111], v[20:23], v[84:87]
    ds_read_b128 v[40:43], v9 offset:18432
    v_mfma_f32_16x16x32_bf16 v[56:59], v[100:103], v[24:27], v[56:59]
    v_mfma_f32_16x16x32_bf16 v[72:75], v[104:107], v[24:27], v[72:75]
    ds_read_b128 v[44:47], v9 offset:36864
    v_mfma_f32_16x16x32_bf16 v[88:91], v[108:111], v[24:27], v[88:91]
    v_mfma_f32_16x16x32_bf16 v[60:63], v[100:103], v[28:31], v[60:63]
    ds_read_b128 v[48:51], v9 offset:55296
    v_mfma_f32_16x16x32_bf16 v[76:79], v[104:107], v[28:31], v[76:79]
    v_mfma_f32_16x16x32_bf16 v[92:95], v[108:111], v[28:31], v[92:95]
    v_mfma_f32_16x16x32_bf16 v[64:67], v[100:103], v[32:35], v[64:67]
    v_mfma_f32_16x16x32_bf16 v[80:83], v[104:107], v[32:35], v[80:83]
    v_mfma_f32_16x16x32_bf16 v[96:99], v[108:111], v[32:35], v[96:99]
    buffer_load_dwordx4 v[100:103], v3, s[16:19], s45 offen offset:0 sc1
    buffer_load_dwordx4 v[104:107], v3, s[16:19], s45 offen offset:1024 sc1
    buffer_load_dwordx4 v[108:111], v3, s[16:19], s45 offen offset:2048 sc1
    s_add_u32 s45, s45, 3072
    s_waitcnt vmcnt(9) lgkmcnt(0)
    v_mfma_f32_16x16x32_bf16 v[52:55], v[112:115], v[36:39], v[52:55]
    ds_read_b128 v[20:23], v8 offset:128
    v_mfma_f32_16x16x32_bf16 v[68:71], v[116:119], v[36:39], v[68:71]
    v_mfma_f32_16x16x32_bf16 v[84:87], v[120:123], v[36:39], v[84:87]
    ds_read_b128 v[24:27], v8 offset:18560
    v_mfma_f32_16x16x32_bf16 v[56:59], v[112:115], v[40:43], v[56:59]
    v_mfma_f32_16x16x32_bf16 v[72:75], v[116:119], v[40:43], v[72:75]
    ds_read_b128 v[28:31], v8 offset:36992
    v_mfma_f32_16x16x32_bf16 v[88:91], v[120:123], v[40:43], v[88:91]
    v_mfma_f32_16x16x32_bf16 v[60:63], v[112:115], v[44:47], v[60:63]
    ds_read_b128 v[32:35], v8 offset:55424
    v_mfma_f32_16x16x32_bf16 v[76:79], v[116:119], v[44:47], v[76:79]
    v_mfma_f32_16x16x32_bf16 v[92:95], v[120:123], v[44:47], v[92:95]
    v_mfma_f32_16x16x32_bf16 v[64:67], v[112:115], v[48:51], v[64:67]
    v_mfma_f32_16x16x32_bf16 v[80:83], v[116:119], v[48:51], v[80:83]
    v_mfma_f32_16x16x32_bf16 v[96:99], v[120:123], v[48:51], v[96:99]
    buffer_load_dwordx4 v[112:115], v3, s[16:19], s45 offen offset:0 sc1
    buffer_load_dwordx4 v[116:119], v3, s[16:19], s45 offen offset:1024 sc1
    buffer_load_dwordx4 v[120:123], v3, s[16:19], s45 offen offset:2048 sc1
    s_add_u32 s45, s45, 3072
    s_waitcnt vmcnt(9) lgkmcnt(0)
    v_mfma_f32_16x16x32_bf16 v[52:55], v[124:127], v[20:23], v[52:55]
    ds_read_b128 v[36:39], v9 offset:128
    v_mfma_f32_16x16x32_bf16 v[68:71], v[128:131], v[20:23], v[68:71]
    v_mfma_f32_16x16x32_bf16 v[84:87], v[132:135], v[20:23], v[84:87]
    ds_read_b128 v[40:43], v9 offset:18560
    v_mfma_f32_16x16x32_bf16 v[56:59], v[124:127], v[24:27], v[56:59]
    v_mfma_f32_16x16x32_bf16 v[72:75], v[128:131], v[24:27], v[72:75]
    ds_read_b128 v[44:47], v9 offset:36992
    v_mfma_f32_16x16x32_bf16 v[88:91], v[132:135], v[24:27], v[88:91]
    v_mfma_f32_16x16x32_bf16 v[60:63], v[124:127], v[28:31], v[60:63]
    ds_read_b128 v[48:51], v9 offset:55424
    v_mfma_f32_16x16x32_bf16 v[76:79], v[128:131], v[28:31], v[76:79]
    v_mfma_f32_16x16x32_bf16 v[92:95], v[132:135], v[28:31], v[92:95]
    v_mfma_f32_16x16x32_bf16 v[64:67], v[124:127], v[32:35], v[64:67]
    v_mfma_f32_16x16x32_bf16 v[80:83], v[128:131], v[32:35], v[80:83]
    v_mfma_f32_16x16x32_bf16 v[96:99], v[132:135], v[32:35], v[96:99]
    buffer_load_dwordx4 v[124:127], v3, s[16:19], s45 offen offset:0 sc1
    buffer_load_dwordx4 v[128:131], v3, s[16:19], s45 offen offset:1024 sc1
    buffer_load_dwordx4 v[132:135], v3, s[16:19], s45 offen offset:2048 sc1
    s_add_u32 s45, s45, 3072
    s_waitcnt vmcnt(9) lgkmcnt(0)
    v_mfma_f32_16x16x32_bf16 v[52:55], v[136:139], v[36:39], v[52:55]
    ds_read_b128 v[20:23], v8 offset:256
    v_mfma_f32_16x16x32_bf16 v[68:71], v[140:143], v[36:39], v[68:71]
    v_mfma_f32_16x16x32_bf16 v[84:87], v[144:147], v[36:39], v[84:87]
    ds_read_b128 v[24:27], v8 offset:18688
    v_mfma_f32_16x16x32_bf16 v[56:59], v[136:139], v[40:43], v[56:59]
    v_mfma_f32_16x16x32_bf16 v[72:75], v[140:143], v[40:43], v[72:75]
    ds_read_b128 v[28:31], v8 offset:37120
    v_mfma_f32_16x16x32_bf16 v[88:91], v[144:147], v[40:43], v[88:91]
    v_mfma_f32_16x16x32_bf16 v[60:63], v[136:139], v[44:47], v[60:63]
    ds_read_b128 v[32:35], v8 offset:55552
    v_mfma_f32_16x16x32_bf16 v[76:79], v[140:143], v[44:47], v[76:79]
    v_mfma_f32_16x16x32_bf16 v[92:95], v[144:147], v[44:47], v[92:95]
    v_mfma_f32_16x16x32_bf16 v[64:67], v[136:139], v[48:51], v[64:67]
    v_mfma_f32_16x16x32_bf16 v[80:83], v[140:143], v[48:51], v[80:83]
    v_mfma_f32_16x16x32_bf16 v[96:99], v[144:147], v[48:51], v[96:99]
    buffer_load_dwordx4 v[136:139], v3, s[16:19], s45 offen offset:0 sc1
    buffer_load_dwordx4 v[140:143], v3, s[16:19], s45 offen offset:1024 sc1
    buffer_load_dwordx4 v[144:147], v3, s[16:19], s45 offen offset:2048 sc1
    s_add_u32 s45, s45, 3072
    s_waitcnt vmcnt(9) lgkmcnt(0)
    v_mfma_f32_16x16x32_bf16 v[52:55], v[100:103], v[20:23], v[52:55]
    ds_read_b128 v[36:39], v9 offset:256
    v_mfma_f32_16x16x32_bf16 v[68:71], v[104:107], v[20:23], v[68:71]
    v_mfma_f32_16x16x32_bf16 v[84:87], v[108:111], v[20:23], v[84:87]
    ds_read_b128 v[40:43], v9 offset:18688
    v_mfma_f32_16x16x32_bf16 v[56:59], v[100:103], v[24:27], v[56:59]
    v_mfma_f32_16x16x32_bf16 v[72:75], v[104:107], v[24:27], v[72:75]
    ds_read_b128 v[44:47], v9 offset:37120
    v_mfma_f32_16x16x32_bf16 v[88:91], v[108:111], v[24:27], v[88:91]
    v_mfma_f32_16x16x32_bf16 v[60:63], v[100:103], v[28:31], v[60:63]
    ds_read_b128 v[48:51], v9 offset:55552
    v_mfma_f32_16x16x32_bf16 v[76:79], v[104:107], v[28:31], v[76:79]
    v_mfma_f32_16x16x32_bf16 v[92:95], v[108:111], v[28:31], v[92:95]
    v_mfma_f32_16x16x32_bf16 v[64:67], v[100:103], v[32:35], v[64:67]
    v_mfma_f32_16x16x32_bf16 v[80:83], v[104:107], v[32:35], v[80:83]
    v_mfma_f32_16x16x32_bf16 v[96:99], v[108:111], v[32:35], v[96:99]
    buffer_load_dwordx4 v[100:103], v3, s[16:19], s45 offen offset:0 sc1
    buffer_load_dwordx4 v[104:107], v3, s[16:19], s45 offen offset:1024 sc1
    buffer_load_dwordx4 v[108:111], v3, s[16:19], s45 offen offset:2048 sc1
    s_add_u32 s45, s45, 3072
    s_waitcnt vmcnt(9) lgkmcnt(0)
    v_mfma_f32_16x16x32_bf16 v[52:55], v[112:115], v[36:39], v[52:55]
    ds_read_b128 v[20:23], v8 offset:384
    v_mfma_f32_16x16x32_bf16 v[68:71], v[116:119], v[36:39], v[68:71]
    v_mfma_f32_16x16x32_bf16 v[84:87], v[120:123], v[36:39], v[84:87]
    ds_read_b128 v[24:27], v8 offset:18816
    v_mfma_f32_16x16x32_bf16 v[56:59], v[112:115], v[40:43], v[56:59]
    v_mfma_f32_16x16x32_bf16 v[72:75], v[116:119], v[40:43], v[72:75]
    ds_read_b128 v[28:31], v8 offset:37248
    v_mfma_f32_16x16x32_bf16 v[88:91], v[120:123], v[40:43], v[88:91]
    v_mfma_f32_16x16x32_bf16 v[60:63], v[112:115], v[44:47], v[60:63]
    ds_read_b128 v[32:35], v8 offset:55680
    v_mfma_f32_16x16x32_bf16 v[76:79], v[116:119], v[44:47], v[76:79]
    v_mfma_f32_16x16x32_bf16 v[92:95], v[120:123], v[44:47], v[92:95]
    v_mfma_f32_16x16x32_bf16 v[64:67], v[112:115], v[48:51], v[64:67]
    v_mfma_f32_16x16x32_bf16 v[80:83], v[116:119], v[48:51], v[80:83]
    v_mfma_f32_16x16x32_bf16 v[96:99], v[120:123], v[48:51], v[96:99]
    buffer_load_dwordx4 v[112:115], v3, s[16:19], s45 offen offset:0 sc1
    buffer_load_dwordx4 v[116:119], v3, s[16:19], s45 offen offset:1024 sc1
    buffer_load_dwordx4 v[120:123], v3, s[16:19], s45 offen offset:2048 sc1
    s_add_u32 s45, s45, 3072
    s_waitcnt vmcnt(9) lgkmcnt(0)
    v_mfma_f32_16x16x32_bf16 v[52:55], v[124:127], v[20:23], v[52:55]
    ds_read_b128 v[36:39], v9 offset:384
    v_mfma_f32_16x16x32_bf16 v[68:71], v[128:131], v[20:23], v[68:71]
    v_mfma_f32_16x16x32_bf16 v[84:87], v[132:135], v[20:23], v[84:87]
    ds_read_b128 v[40:43], v9 offset:18816
    v_mfma_f32_16x16x32_bf16 v[56:59], v[124:127], v[24:27], v[56:59]
    v_mfma_f32_16x16x32_bf16 v[72:75], v[128:131], v[24:27], v[72:75]
    ds_read_b128 v[44:47], v9 offset:37248
    v_mfma_f32_16x16x32_bf16 v[88:91], v[132:135], v[24:27], v[88:91]
    v_mfma_f32_16x16x32_bf16 v[60:63], v[124:127], v[28:31], v[60:63]
    ds_read_b128 v[48:51], v9 offset:55680
    v_mfma_f32_16x16x32_bf16 v[76:79], v[128:131], v[28:31], v[76:79]
    v_mfma_f32_16x16x32_bf16 v[92:95], v[132:135], v[28:31], v[92:95]
    v_mfma_f32_16x16x32_bf16 v[64:67], v[124:127], v[32:35], v[64:67]
    v_mfma_f32_16x16x32_bf16 v[80:83], v[128:131], v[32:35], v[80:83]
    v_mfma_f32_16x16x32_bf16 v[96:99], v[132:135], v[32:35], v[96:99]
    buffer_load_dwordx4 v[124:127], v3, s[16:19], s45 offen offset:0 sc1
    buffer_load_dwordx4 v[128:131], v3, s[16:19], s45 offen offset:1024 sc1
    buffer_load_dwordx4 v[132:135], v3, s[16:19], s45 offen offset:2048 sc1
    s_add_u32 s45, s45, 3072
    s_waitcnt vmcnt(9) lgkmcnt(0)
    v_mfma_f32_16x16x32_bf16 v[52:55], v[136:139], v[36:39], v[52:55]
    ds_read_b128 v[20:23], v8 offset:512
    v_mfma_f32_16x16x32_bf16 v[68:71], v[140:143], v[36:39], v[68:71]
    v_mfma_f32_16x16x32_bf16 v[84:87], v[144:147], v[36:39], v[84:87]
    ds_read_b128 v[24:27], v8 offset:18944
    v_mfma_f32_16x16x32_bf16 v[56:59], v[136:139], v[40:43], v[56:59]
    v_mfma_f32_16x16x32_bf16 v[72:75], v[140:143], v[40:43], v[72:75]
    ds_read_b128 v[28:31], v8 offset:37376
    v_mfma_f32_16x16x32_bf16 v[88:91], v[144:147], v[40:43], v[88:91]
    v_mfma_f32_16x16x32_bf16 v[60:63], v[136:139], v[44:47], v[60:63]
    ds_read_b128 v[32:35], v8 offset:55808
    v_mfma_f32_16x16x32_bf16 v[76:79], v[140:143], v[44:47], v[76:79]
    v_mfma_f32_16x16x32_bf16 v[92:95], v[144:147], v[44:47], v[92:95]
    v_mfma_f32_16x16x32_bf16 v[64:67], v[136:139], v[48:51], v[64:67]
    v_mfma_f32_16x16x32_bf16 v[80:83], v[140:143], v[48:51], v[80:83]
    v_mfma_f32_16x16x32_bf16 v[96:99], v[144:147], v[48:51], v[96:99]
    buffer_load_dwordx4 v[136:139], v3, s[16:19], s45 offen offset:0 sc1
    buffer_load_dwordx4 v[140:143], v3, s[16:19], s45 offen offset:1024 sc1
    buffer_load_dwordx4 v[144:147], v3, s[16:19], s45 offen offset:2048 sc1
    s_add_u32 s45, s45, 3072
    s_waitcnt vmcnt(9) lgkmcnt(0)
    v_mfma_f32_16x16x32_bf16 v[52:55], v[100:103], v[20:23], v[52:55]
    ds_read_b128 v[36:39], v9 offset:512
    v_mfma_f32_16x16x32_bf16 v[68:71], v[104:107], v[20:23], v[68:71]
    v_mfma_f32_16x16x32_bf16 v[84:87], v[108:111], v[20:23], v[84:87]
    ds_read_b128 v[40:43], v9 offset:18944
    v_mfma_f32_16x16x32_bf16 v[56:59], v[100:103], v[24:27], v[56:59]
    v_mfma_f32_16x16x32_bf16 v[72:75], v[104:107], v[24:27], v[72:75]
    ds_read_b128 v[44:47], v9 offset:37376
    v_mfma_f32_16x16x32_bf16 v[88:91], v[108:111], v[24:27], v[88:91]
    v_mfma_f32_16x16x32_bf16 v[60:63], v[100:103], v[28:31], v[60:63]
    ds_read_b128 v[48:51], v9 offset:55808
    v_mfma_f32_16x16x32_bf16 v[76:79], v[104:107], v[28:31], v[76:79]
    v_mfma_f32_16x16x32_bf16 v[92:95], v[108:111], v[28:31], v[92:95]
    v_mfma_f32_16x16x32_bf16 v[64:67], v[100:103], v[32:35], v[64:67]
    v_mfma_f32_16x16x32_bf16 v[80:83], v[104:107], v[32:35], v[80:83]
    v_mfma_f32_16x16x32_bf16 v[96:99], v[108:111], v[32:35], v[96:99]
    buffer_load_dwordx4 v[100:103], v3, s[16:19], s45 offen offset:0 sc1
    buffer_load_dwordx4 v[104:107], v3, s[16:19], s45 offen offset:1024 sc1
    buffer_load_dwordx4 v[108:111], v3, s[16:19], s45 offen offset:2048 sc1
    s_add_u32 s45, s45, 3072
    s_waitcnt vmcnt(9) lgkmcnt(0)
    v_mfma_f32_16x16x32_bf16 v[52:55], v[112:115], v[36:39], v[52:55]
    ds_read_b128 v[20:23], v8 offset:640
    v_mfma_f32_16x16x32_bf16 v[68:71], v[116:119], v[36:39], v[68:71]
    v_mfma_f32_16x16x32_bf16 v[84:87], v[120:123], v[36:39], v[84:87]
    ds_read_b128 v[24:27], v8 offset:19072
    v_mfma_f32_16x16x32_bf16 v[56:59], v[112:115], v[40:43], v[56:59]
    v_mfma_f32_16x16x32_bf16 v[72:75], v[116:119], v[40:43], v[72:75]
    ds_read_b128 v[28:31], v8 offset:37504
    v_mfma_f32_16x16x32_bf16 v[88:91], v[120:123], v[40:43], v[88:91]
    v_mfma_f32_16x16x32_bf16 v[60:63], v[112:115], v[44:47], v[60:63]
    ds_read_b128 v[32:35], v8 offset:55936
    v_mfma_f32_16x16x32_bf16 v[76:79], v[116:119], v[44:47], v[76:79]
    v_mfma_f32_16x16x32_bf16 v[92:95], v[120:123], v[44:47], v[92:95]
    v_mfma_f32_16x16x32_bf16 v[64:67], v[112:115], v[48:51], v[64:67]
    v_mfma_f32_16x16x32_bf16 v[80:83], v[116:119], v[48:51], v[80:83]
    v_mfma_f32_16x16x32_bf16 v[96:99], v[120:123], v[48:51], v[96:99]
    buffer_load_dwordx4 v[112:115], v3, s[16:19], s45 offen offset:0 sc1
    buffer_load_dwordx4 v[116:119], v3, s[16:19], s45 offen offset:1024 sc1
    buffer_load_dwordx4 v[120:123], v3, s[16:19], s45 offen offset:2048 sc1
    s_add_u32 s45, s45, 3072
    s_waitcnt vmcnt(9) lgkmcnt(0)
    v_mfma_f32_16x16x32_bf16 v[52:55], v[124:127], v[20:23], v[52:55]
    ds_read_b128 v[36:39], v9 offset:640
    v_mfma_f32_16x16x32_bf16 v[68:71], v[128:131], v[20:23], v[68:71]
    v_mfma_f32_16x16x32_bf16 v[84:87], v[132:135], v[20:23], v[84:87]
    ds_read_b128 v[40:43], v9 offset:19072
    v_mfma_f32_16x16x32_bf16 v[56:59], v[124:127], v[24:27], v[56:59]
    v_mfma_f32_16x16x32_bf16 v[72:75], v[128:131], v[24:27], v[72:75]
    ds_read_b128 v[44:47], v9 offset:37504
    v_mfma_f32_16x16x32_bf16 v[88:91], v[132:135], v[24:27], v[88:91]
    v_mfma_f32_16x16x32_bf16 v[60:63], v[124:127], v[28:31], v[60:63]
    ds_read_b128 v[48:51], v9 offset:55936
    v_mfma_f32_16x16x32_bf16 v[76:79], v[128:131], v[28:31], v[76:79]
    v_mfma_f32_16x16x32_bf16 v[92:95], v[132:135], v[28:31], v[92:95]
    v_mfma_f32_16x16x32_bf16 v[64:67], v[124:127], v[32:35], v[64:67]
    v_mfma_f32_16x16x32_bf16 v[80:83], v[128:131], v[32:35], v[80:83]
    v_mfma_f32_16x16x32_bf16 v[96:99], v[132:135], v[32:35], v[96:99]
    buffer_load_dwordx4 v[124:127], v3, s[16:19], s45 offen offset:0 sc1
    buffer_load_dwordx4 v[128:131], v3, s[16:19], s45 offen offset:1024 sc1
    buffer_load_dwordx4 v[132:135], v3, s[16:19], s45 offen offset:2048 sc1
    s_add_u32 s45, s45, 3072
    s_waitcnt vmcnt(9) lgkmcnt(0)
    v_mfma_f32_16x16x32_bf16 v[52:55], v[136:139], v[36:39], v[52:55]
    ds_read_b128 v[20:23], v8 offset:768
    v_mfma_f32_16x16x32_bf16 v[68:71], v[140:143], v[36:39], v[68:71]
    v_mfma_f32_16x16x32_bf16 v[84:87], v[144:147], v[36:39], v[84:87]
    ds_read_b128 v[24:27], v8 offset:19200
    v_mfma_f32_16x16x32_bf16 v[56:59], v[136:139], v[40:43], v[56:59]
    v_mfma_f32_16x16x32_bf16 v[72:75], v[140:143], v[40:43], v[72:75]
    ds_read_b128 v[28:31], v8 offset:37632
    v_mfma_f32_16x16x32_bf16 v[88:91], v[144:147], v[40:43], v[88:91]
    v_mfma_f32_16x16x32_bf16 v[60:63], v[136:139], v[44:47], v[60:63]
    ds_read_b128 v[32:35], v8 offset:56064
    v_mfma_f32_16x16x32_bf16 v[76:79], v[140:143], v[44:47], v[76:79]
    v_mfma_f32_16x16x32_bf16 v[92:95], v[144:147], v[44:47], v[92:95]
    v_mfma_f32_16x16x32_bf16 v[64:67], v[136:139], v[48:51], v[64:67]
    v_mfma_f32_16x16x32_bf16 v[80:83], v[140:143], v[48:51], v[80:83]
    v_mfma_f32_16x16x32_bf16 v[96:99], v[144:147], v[48:51], v[96:99]
    buffer_load_dwordx4 v[136:139], v3, s[16:19], s45 offen offset:0 sc1
    buffer_load_dwordx4 v[140:143], v3, s[16:19], s45 offen offset:1024 sc1
    buffer_load_dwordx4 v[144:147], v3, s[16:19], s45 offen offset:2048 sc1
    s_add_u32 s45, s45, 3072
    s_waitcnt vmcnt(9) lgkmcnt(0)
    v_mfma_f32_16x16x32_bf16 v[52:55], v[100:103], v[20:23], v[52:55]
    ds_read_b128 v[36:39], v9 offset:768
    v_mfma_f32_16x16x32_bf16 v[68:71], v[104:107], v[20:23], v[68:71]
    v_mfma_f32_16x16x32_bf16 v[84:87], v[108:111], v[20:23], v[84:87]
    ds_read_b128 v[40:43], v9 offset:19200
    v_mfma_f32_16x16x32_bf16 v[56:59], v[100:103], v[24:27], v[56:59]
    v_mfma_f32_16x16x32_bf16 v[72:75], v[104:107], v[24:27], v[72:75]
    ds_read_b128 v[44:47], v9 offset:37632
    v_mfma_f32_16x16x32_bf16 v[88:91], v[108:111], v[24:27], v[88:91]
    v_mfma_f32_16x16x32_bf16 v[60:63], v[100:103], v[28:31], v[60:63]
    ds_read_b128 v[48:51], v9 offset:56064
    v_mfma_f32_16x16x32_bf16 v[76:79], v[104:107], v[28:31], v[76:79]
    v_mfma_f32_16x16x32_bf16 v[92:95], v[108:111], v[28:31], v[92:95]
    v_mfma_f32_16x16x32_bf16 v[64:67], v[100:103], v[32:35], v[64:67]
    v_mfma_f32_16x16x32_bf16 v[80:83], v[104:107], v[32:35], v[80:83]
    v_mfma_f32_16x16x32_bf16 v[96:99], v[108:111], v[32:35], v[96:99]
    buffer_load_dwordx4 v[100:103], v3, s[16:19], s45 offen offset:0 sc1
    buffer_load_dwordx4 v[104:107], v3, s[16:19], s45 offen offset:1024 sc1
    buffer_load_dwordx4 v[108:111], v3, s[16:19], s45 offen offset:2048 sc1
    s_add_u32 s45, s45, 3072
    s_waitcnt vmcnt(9) lgkmcnt(0)
    v_mfma_f32_16x16x32_bf16 v[52:55], v[112:115], v[36:39], v[52:55]
    ds_read_b128 v[20:23], v8 offset:896
    v_mfma_f32_16x16x32_bf16 v[68:71], v[116:119], v[36:39], v[68:71]
    v_mfma_f32_16x16x32_bf16 v[84:87], v[120:123], v[36:39], v[84:87]
    ds_read_b128 v[24:27], v8 offset:19328
    v_mfma_f32_16x16x32_bf16 v[56:59], v[112:115], v[40:43], v[56:59]
    v_mfma_f32_16x16x32_bf16 v[72:75], v[116:119], v[40:43], v[72:75]
    ds_read_b128 v[28:31], v8 offset:37760
    v_mfma_f32_16x16x32_bf16 v[88:91], v[120:123], v[40:43], v[88:91]
    v_mfma_f32_16x16x32_bf16 v[60:63], v[112:115], v[44:47], v[60:63]
    ds_read_b128 v[32:35], v8 offset:56192
    v_mfma_f32_16x16x32_bf16 v[76:79], v[116:119], v[44:47], v[76:79]
    v_mfma_f32_16x16x32_bf16 v[92:95], v[120:123], v[44:47], v[92:95]
    v_mfma_f32_16x16x32_bf16 v[64:67], v[112:115], v[48:51], v[64:67]
    v_mfma_f32_16x16x32_bf16 v[80:83], v[116:119], v[48:51], v[80:83]
    v_mfma_f32_16x16x32_bf16 v[96:99], v[120:123], v[48:51], v[96:99]
    buffer_load_dwordx4 v[112:115], v3, s[16:19], s45 offen offset:0 sc1
    buffer_load_dwordx4 v[116:119], v3, s[16:19], s45 offen offset:1024 sc1
    buffer_load_dwordx4 v[120:123], v3, s[16:19], s45 offen offset:2048 sc1
    s_add_u32 s45, s45, 3072
    s_waitcnt vmcnt(9) lgkmcnt(0)
    v_mfma_f32_16x16x32_bf16 v[52:55], v[124:127], v[20:23], v[52:55]
    ds_read_b128 v[36:39], v9 offset:896
    v_mfma_f32_16x16x32_bf16 v[68:71], v[128:131], v[20:23], v[68:71]
    v_mfma_f32_16x16x32_bf16 v[84:87], v[132:135], v[20:23], v[84:87]
    ds_read_b128 v[40:43], v9 offset:19328
    v_mfma_f32_16x16x32_bf16 v[56:59], v[124:127], v[24:27], v[56:59]
    v_mfma_f32_16x16x32_bf16 v[72:75], v[128:131], v[24:27], v[72:75]
    ds_read_b128 v[44:47], v9 offset:37760
    v_mfma_f32_16x16x32_bf16 v[88:91], v[132:135], v[24:27], v[88:91]
    v_mfma_f32_16x16x32_bf16 v[60:63], v[124:127], v[28:31], v[60:63]
    ds_read_b128 v[48:51], v9 offset:56192
    v_mfma_f32_16x16x32_bf16 v[76:79], v[128:131], v[28:31], v[76:79]
    v_mfma_f32_16x16x32_bf16 v[92:95], v[132:135], v[28:31], v[92:95]
    v_mfma_f32_16x16x32_bf16 v[64:67], v[124:127], v[32:35], v[64:67]
    v_mfma_f32_16x16x32_bf16 v[80:83], v[128:131], v[32:35], v[80:83]
    v_mfma_f32_16x16x32_bf16 v[96:99], v[132:135], v[32:35], v[96:99]
    s_add_u32 s45, s45, 0x5f2800
    buffer_load_dwordx4 v[124:127], v3, s[16:19], s45 offen offset:0 sc1
    buffer_load_dwordx4 v[128:131], v3, s[16:19], s45 offen offset:1024 sc1
    buffer_load_dwordx4 v[132:135], v3, s[16:19], s45 offen offset:2048 sc1
    s_add_u32 s45, s45, 3072
    s_waitcnt vmcnt(9) lgkmcnt(0)
    v_mfma_f32_16x16x32_bf16 v[52:55], v[136:139], v[36:39], v[52:55]
    ds_read_b128 v[20:23], v8 offset:1024
    v_mfma_f32_16x16x32_bf16 v[68:71], v[140:143], v[36:39], v[68:71]
    v_mfma_f32_16x16x32_bf16 v[84:87], v[144:147], v[36:39], v[84:87]
    ds_read_b128 v[24:27], v8 offset:19456
    v_mfma_f32_16x16x32_bf16 v[56:59], v[136:139], v[40:43], v[56:59]
    v_mfma_f32_16x16x32_bf16 v[72:75], v[140:143], v[40:43], v[72:75]
    ds_read_b128 v[28:31], v8 offset:37888
    v_mfma_f32_16x16x32_bf16 v[88:91], v[144:147], v[40:43], v[88:91]
    v_mfma_f32_16x16x32_bf16 v[60:63], v[136:139], v[44:47], v[60:63]
    ds_read_b128 v[32:35], v8 offset:56320
    v_mfma_f32_16x16x32_bf16 v[76:79], v[140:143], v[44:47], v[76:79]
    v_mfma_f32_16x16x32_bf16 v[92:95], v[144:147], v[44:47], v[92:95]
    v_mfma_f32_16x16x32_bf16 v[64:67], v[136:139], v[48:51], v[64:67]
    v_mfma_f32_16x16x32_bf16 v[80:83], v[140:143], v[48:51], v[80:83]
    v_mfma_f32_16x16x32_bf16 v[96:99], v[144:147], v[48:51], v[96:99]
    buffer_load_dwordx4 v[136:139], v3, s[16:19], s45 offen offset:0 sc1
    buffer_load_dwordx4 v[140:143], v3, s[16:19], s45 offen offset:1024 sc1
    buffer_load_dwordx4 v[144:147], v3, s[16:19], s45 offen offset:2048 sc1
    s_add_u32 s45, s45, 3072
    s_waitcnt vmcnt(9) lgkmcnt(0)
    v_mfma_f32_16x16x32_bf16 v[52:55], v[100:103], v[20:23], v[52:55]
    ds_read_b128 v[36:39], v9 offset:1024
    v_mfma_f32_16x16x32_bf16 v[68:71], v[104:107], v[20:23], v[68:71]
    v_mfma_f32_16x16x32_bf16 v[84:87], v[108:111], v[20:23], v[84:87]
    ds_read_b128 v[40:43], v9 offset:19456
    v_mfma_f32_16x16x32_bf16 v[56:59], v[100:103], v[24:27], v[56:59]
    v_mfma_f32_16x16x32_bf16 v[72:75], v[104:107], v[24:27], v[72:75]
    ds_read_b128 v[44:47], v9 offset:37888
    v_mfma_f32_16x16x32_bf16 v[88:91], v[108:111], v[24:27], v[88:91]
    v_mfma_f32_16x16x32_bf16 v[60:63], v[100:103], v[28:31], v[60:63]
    ds_read_b128 v[48:51], v9 offset:56320
    v_mfma_f32_16x16x32_bf16 v[76:79], v[104:107], v[28:31], v[76:79]
    v_mfma_f32_16x16x32_bf16 v[92:95], v[108:111], v[28:31], v[92:95]
    v_mfma_f32_16x16x32_bf16 v[64:67], v[100:103], v[32:35], v[64:67]
    v_mfma_f32_16x16x32_bf16 v[80:83], v[104:107], v[32:35], v[80:83]
    v_mfma_f32_16x16x32_bf16 v[96:99], v[108:111], v[32:35], v[96:99]
    buffer_load_dwordx4 v[100:103], v3, s[16:19], s45 offen offset:0 sc1
    buffer_load_dwordx4 v[104:107], v3, s[16:19], s45 offen offset:1024 sc1
    buffer_load_dwordx4 v[108:111], v3, s[16:19], s45 offen offset:2048 sc1
    s_add_u32 s45, s45, 3072
    s_waitcnt vmcnt(9) lgkmcnt(0)
    v_mfma_f32_16x16x32_bf16 v[52:55], v[112:115], v[36:39], v[52:55]
    v_mfma_f32_16x16x32_bf16 v[68:71], v[116:119], v[36:39], v[68:71]
    v_mfma_f32_16x16x32_bf16 v[84:87], v[120:123], v[36:39], v[84:87]
    v_mfma_f32_16x16x32_bf16 v[56:59], v[112:115], v[40:43], v[56:59]
    v_mfma_f32_16x16x32_bf16 v[72:75], v[116:119], v[40:43], v[72:75]
    v_mfma_f32_16x16x32_bf16 v[88:91], v[120:123], v[40:43], v[88:91]
    v_mfma_f32_16x16x32_bf16 v[60:63], v[112:115], v[44:47], v[60:63]
    v_mfma_f32_16x16x32_bf16 v[76:79], v[116:119], v[44:47], v[76:79]
    v_mfma_f32_16x16x32_bf16 v[92:95], v[120:123], v[44:47], v[92:95]
    v_mfma_f32_16x16x32_bf16 v[64:67], v[112:115], v[48:51], v[64:67]
    v_mfma_f32_16x16x32_bf16 v[80:83], v[116:119], v[48:51], v[80:83]
    v_mfma_f32_16x16x32_bf16 v[96:99], v[120:123], v[48:51], v[96:99]
    buffer_load_dwordx4 v[112:115], v3, s[16:19], s45 offen offset:0 sc1
    buffer_load_dwordx4 v[116:119], v3, s[16:19], s45 offen offset:1024 sc1
    buffer_load_dwordx4 v[120:123], v3, s[16:19], s45 offen offset:2048 sc1
    s_add_u32 s45, s45, 3072
    v_and_b32 v12, 15, v1
    v_lshlrev_b32 v13, 3, v12
    v_add_u32 v13, 147456, v13
    ds_read_b64 v[160:161], v13 offset:0
    ds_read_b64 v[162:163], v13 offset:128
    ds_read_b64 v[164:165], v13 offset:256
    ds_read_b64 v[166:167], v13 offset:384
    v_lshrrev_b32 v14, 4, v1
    v_lshlrev_b32 v14, 4, v14
    s_mul_i32 s31, s3, 192
    s_add_u32 s31, s31, 148480
    v_add_u32 v14, s31, v14
    ds_read_b128 v[148:151], v14 offset:0
    ds_read_b128 v[152:155], v14 offset:64
    ds_read_b128 v[156:159], v14 offset:128
    s_mov_b32 s54, 0xbdd2d3e8
    s_mov_b32 s55, 0xbdd2d3e8
    s_mov_b32 s58, 1.0
    s_mov_b32 s59, 1.0
    v_mov_b32 v18, 0xc0135761
    v_mov_b32 v19, 0xc0135761
    v_lshrrev_b32 v13, 4, v1
    v_lshrrev_b32 v14, 1, v13
    s_mul_i32 s31, s3, 6
    v_add_u32 v14, s31, v14
    v_and_b32 v15, 7, v12
    v_mul_u32_u24 v16, 1152, v12
    v_and_b32 v13, 1, v13
    v_lshl_add_u32 v16, v13, 3, v16
    v_add_u32 v16, 73728, v16
    v_add_u32 v13, 0, v14
    v_xor_b32 v13, v13, v15
    v_lshl_add_u32 v48, v13, 4, v16
    v_add_u32 v13, 2, v14
    v_xor_b32 v13, v13, v15
    v_lshl_add_u32 v49, v13, 4, v16
    v_add_u32 v13, 4, v14
    v_xor_b32 v13, v13, v15
    v_lshl_add_u32 v50, v13, 4, v16
    s_waitcnt lgkmcnt(0)
    v_mul_f32 v20, v161, v148
    v_mul_f32 v21, v161, v149
    v_mul_f32 v22, v161, v150
    v_mul_f32 v23, v161, v151
    v_fma_f32 v52, v52, v160, -v20
    v_fma_f32 v53, v53, v160, -v21
    v_fma_f32 v54, v54, v160, -v22
    v_fma_f32 v55, v55, v160, -v23
    v_mul_f32 v20, v161, v152
    v_mul_f32 v21, v161, v153
    v_mul_f32 v22, v161, v154
    v_mul_f32 v23, v161, v155
    v_fma_f32 v68, v68, v160, -v20
    v_fma_f32 v69, v69, v160, -v21
    v_fma_f32 v70, v70, v160, -v22
    v_fma_f32 v71, v71, v160, -v23
    v_mul_f32 v20, v161, v156
    v_mul_f32 v21, v161, v157
    v_mul_f32 v22, v161, v158
    v_mul_f32 v23, v161, v159
    v_fma_f32 v84, v84, v160, -v20
    v_fma_f32 v85, v85, v160, -v21
    v_fma_f32 v86, v86, v160, -v22
    v_fma_f32 v87, v87, v160, -v23
    v_pk_mul_f32 v[24:25], v[52:53], v[52:53]
    v_pk_mul_f32 v[26:27], v[54:55], v[54:55]
    v_pk_mul_f32 v[28:29], v[68:69], v[68:69]
    v_pk_mul_f32 v[30:31], v[70:71], v[70:71]
    v_pk_mul_f32 v[32:33], v[84:85], v[84:85]
    v_pk_mul_f32 v[34:35], v[86:87], v[86:87]
    v_pk_fma_f32 v[24:25], v[24:25], s[54:55], v[18:19]
    v_pk_fma_f32 v[26:27], v[26:27], s[54:55], v[18:19]
    v_pk_fma_f32 v[28:29], v[28:29], s[54:55], v[18:19]
    v_pk_fma_f32 v[30:31], v[30:31], s[54:55], v[18:19]
    v_pk_fma_f32 v[32:33], v[32:33], s[54:55], v[18:19]
    v_pk_fma_f32 v[34:35], v[34:35], s[54:55], v[18:19]
    v_pk_mul_f32 v[24:25], v[24:25], v[52:53]
    v_pk_mul_f32 v[26:27], v[26:27], v[54:55]
    v_pk_mul_f32 v[28:29], v[28:29], v[68:69]
    v_pk_mul_f32 v[30:31], v[30:31], v[70:71]
    v_pk_mul_f32 v[32:33], v[32:33], v[84:85]
    v_pk_mul_f32 v[34:35], v[34:35], v[86:87]
    v_exp_f32 v24, v24
    v_exp_f32 v25, v25
    v_exp_f32 v26, v26
    v_exp_f32 v27, v27
    v_exp_f32 v28, v28
    v_exp_f32 v29, v29
    v_exp_f32 v30, v30
    v_exp_f32 v31, v31
    v_exp_f32 v32, v32
    v_exp_f32 v33, v33
    v_exp_f32 v34, v34
    v_exp_f32 v35, v35
    v_pk_add_f32 v[24:25], v[24:25], s[58:59]
    v_pk_add_f32 v[26:27], v[26:27], s[58:59]
    v_pk_add_f32 v[28:29], v[28:29], s[58:59]
    v_pk_add_f32 v[30:31], v[30:31], s[58:59]
    v_pk_add_f32 v[32:33], v[32:33], s[58:59]
    v_pk_add_f32 v[34:35], v[34:35], s[58:59]
    v_rcp_f32 v24, v24
    v_rcp_f32 v25, v25
    v_rcp_f32 v26, v26
    v_rcp_f32 v27, v27
    v_rcp_f32 v28, v28
    v_rcp_f32 v29, v29
    v_rcp_f32 v30, v30
    v_rcp_f32 v31, v31
    v_rcp_f32 v32, v32
    v_rcp_f32 v33, v33
    v_rcp_f32 v34, v34
    v_rcp_f32 v35, v35
    v_pk_mul_f32 v[52:53], v[52:53], v[24:25]
    v_pk_mul_f32 v[54:55], v[54:55], v[26:27]
    v_pk_mul_f32 v[68:69], v[68:69], v[28:29]
    v_pk_mul_f32 v[70:71], v[70:71], v[30:31]
    v_pk_mul_f32 v[84:85], v[84:85], v[32:33]
    v_pk_mul_f32 v[86:87], v[86:87], v[34:35]
    v_cvt_pk_bf16_f32 v36, v52, v53
    v_cvt_pk_bf16_f32 v37, v54, v55
    ds_write_b64 v48, v[36:37] offset:0
    v_cvt_pk_bf16_f32 v38, v68, v69
    v_cvt_pk_bf16_f32 v39, v70, v71
    ds_write_b64 v49, v[38:39] offset:0
    v_cvt_pk_bf16_f32 v40, v84, v85
    v_cvt_pk_bf16_f32 v41, v86, v87
    ds_write_b64 v50, v[40:41] offset:0
    v_mul_f32 v20, v163, v148
    v_mul_f32 v21, v163, v149
    v_mul_f32 v22, v163, v150
    v_mul_f32 v23, v163, v151
    v_fma_f32 v56, v56, v162, -v20
    v_fma_f32 v57, v57, v162, -v21
    v_fma_f32 v58, v58, v162, -v22
    v_fma_f32 v59, v59, v162, -v23
    v_mul_f32 v20, v163, v152
    v_mul_f32 v21, v163, v153
    v_mul_f32 v22, v163, v154
    v_mul_f32 v23, v163, v155
    v_fma_f32 v72, v72, v162, -v20
    v_fma_f32 v73, v73, v162, -v21
    v_fma_f32 v74, v74, v162, -v22
    v_fma_f32 v75, v75, v162, -v23
    v_mul_f32 v20, v163, v156
    v_mul_f32 v21, v163, v157
    v_mul_f32 v22, v163, v158
    v_mul_f32 v23, v163, v159
    v_fma_f32 v88, v88, v162, -v20
    v_fma_f32 v89, v89, v162, -v21
    v_fma_f32 v90, v90, v162, -v22
    v_fma_f32 v91, v91, v162, -v23
    v_pk_mul_f32 v[24:25], v[56:57], v[56:57]
    v_pk_mul_f32 v[26:27], v[58:59], v[58:59]
    v_pk_mul_f32 v[28:29], v[72:73], v[72:73]
    v_pk_mul_f32 v[30:31], v[74:75], v[74:75]
    v_pk_mul_f32 v[32:33], v[88:89], v[88:89]
    v_pk_mul_f32 v[34:35], v[90:91], v[90:91]
    v_pk_fma_f32 v[24:25], v[24:25], s[54:55], v[18:19]
    v_pk_fma_f32 v[26:27], v[26:27], s[54:55], v[18:19]
    v_pk_fma_f32 v[28:29], v[28:29], s[54:55], v[18:19]
    v_pk_fma_f32 v[30:31], v[30:31], s[54:55], v[18:19]
    v_pk_fma_f32 v[32:33], v[32:33], s[54:55], v[18:19]
    v_pk_fma_f32 v[34:35], v[34:35], s[54:55], v[18:19]
    v_pk_mul_f32 v[24:25], v[24:25], v[56:57]
    v_pk_mul_f32 v[26:27], v[26:27], v[58:59]
    v_pk_mul_f32 v[28:29], v[28:29], v[72:73]
    v_pk_mul_f32 v[30:31], v[30:31], v[74:75]
    v_pk_mul_f32 v[32:33], v[32:33], v[88:89]
    v_pk_mul_f32 v[34:35], v[34:35], v[90:91]
    v_exp_f32 v24, v24
    v_exp_f32 v25, v25
    v_exp_f32 v26, v26
    v_exp_f32 v27, v27
    v_exp_f32 v28, v28
    v_exp_f32 v29, v29
    v_exp_f32 v30, v30
    v_exp_f32 v31, v31
    v_exp_f32 v32, v32
    v_exp_f32 v33, v33
    v_exp_f32 v34, v34
    v_exp_f32 v35, v35
    v_pk_add_f32 v[24:25], v[24:25], s[58:59]
    v_pk_add_f32 v[26:27], v[26:27], s[58:59]
    v_pk_add_f32 v[28:29], v[28:29], s[58:59]
    v_pk_add_f32 v[30:31], v[30:31], s[58:59]
    v_pk_add_f32 v[32:33], v[32:33], s[58:59]
    v_pk_add_f32 v[34:35], v[34:35], s[58:59]
    v_rcp_f32 v24, v24
    v_rcp_f32 v25, v25
    v_rcp_f32 v26, v26
    v_rcp_f32 v27, v27
    v_rcp_f32 v28, v28
    v_rcp_f32 v29, v29
    v_rcp_f32 v30, v30
    v_rcp_f32 v31, v31
    v_rcp_f32 v32, v32
    v_rcp_f32 v33, v33
    v_rcp_f32 v34, v34
    v_rcp_f32 v35, v35
    v_pk_mul_f32 v[56:57], v[56:57], v[24:25]
    v_pk_mul_f32 v[58:59], v[58:59], v[26:27]
    v_pk_mul_f32 v[72:73], v[72:73], v[28:29]
    v_pk_mul_f32 v[74:75], v[74:75], v[30:31]
    v_pk_mul_f32 v[88:89], v[88:89], v[32:33]
    v_pk_mul_f32 v[90:91], v[90:91], v[34:35]
    v_cvt_pk_bf16_f32 v36, v56, v57
    v_cvt_pk_bf16_f32 v37, v58, v59
    ds_write_b64 v48, v[36:37] offset:18432
    v_cvt_pk_bf16_f32 v38, v72, v73
    v_cvt_pk_bf16_f32 v39, v74, v75
    ds_write_b64 v49, v[38:39] offset:18432
    v_cvt_pk_bf16_f32 v40, v88, v89
    v_cvt_pk_bf16_f32 v41, v90, v91
    ds_write_b64 v50, v[40:41] offset:18432
    v_mul_f32 v20, v165, v148
    v_mul_f32 v21, v165, v149
    v_mul_f32 v22, v165, v150
    v_mul_f32 v23, v165, v151
    v_fma_f32 v60, v60, v164, -v20
    v_fma_f32 v61, v61, v164, -v21
    v_fma_f32 v62, v62, v164, -v22
    v_fma_f32 v63, v63, v164, -v23
    v_mul_f32 v20, v165, v152
    v_mul_f32 v21, v165, v153
    v_mul_f32 v22, v165, v154
    v_mul_f32 v23, v165, v155
    v_fma_f32 v76, v76, v164, -v20
    v_fma_f32 v77, v77, v164, -v21
    v_fma_f32 v78, v78, v164, -v22
    v_fma_f32 v79, v79, v164, -v23
    v_mul_f32 v20, v165, v156
    v_mul_f32 v21, v165, v157
    v_mul_f32 v22, v165, v158
    v_mul_f32 v23, v165, v159
    v_fma_f32 v92, v92, v164, -v20
    v_fma_f32 v93, v93, v164, -v21
    v_fma_f32 v94, v94, v164, -v22
    v_fma_f32 v95, v95, v164, -v23
    v_pk_mul_f32 v[24:25], v[60:61], v[60:61]
    v_pk_mul_f32 v[26:27], v[62:63], v[62:63]
    v_pk_mul_f32 v[28:29], v[76:77], v[76:77]
    v_pk_mul_f32 v[30:31], v[78:79], v[78:79]
    v_pk_mul_f32 v[32:33], v[92:93], v[92:93]
    v_pk_mul_f32 v[34:35], v[94:95], v[94:95]
    v_pk_fma_f32 v[24:25], v[24:25], s[54:55], v[18:19]
    v_pk_fma_f32 v[26:27], v[26:27], s[54:55], v[18:19]
    v_pk_fma_f32 v[28:29], v[28:29], s[54:55], v[18:19]
    v_pk_fma_f32 v[30:31], v[30:31], s[54:55], v[18:19]
    v_pk_fma_f32 v[32:33], v[32:33], s[54:55], v[18:19]
    v_pk_fma_f32 v[34:35], v[34:35], s[54:55], v[18:19]
    v_pk_mul_f32 v[24:25], v[24:25], v[60:61]
    v_pk_mul_f32 v[26:27], v[26:27], v[62:63]
    v_pk_mul_f32 v[28:29], v[28:29], v[76:77]
    v_pk_mul_f32 v[30:31], v[30:31], v[78:79]
    v_pk_mul_f32 v[32:33], v[32:33], v[92:93]
    v_pk_mul_f32 v[34:35], v[34:35], v[94:95]
    v_exp_f32 v24, v24
    v_exp_f32 v25, v25
    v_exp_f32 v26, v26
    v_exp_f32 v27, v27
    v_exp_f32 v28, v28
    v_exp_f32 v29, v29
    v_exp_f32 v30, v30
    v_exp_f32 v31, v31
    v_exp_f32 v32, v32
    v_exp_f32 v33, v33
    v_exp_f32 v34, v34
    v_exp_f32 v35, v35
    v_pk_add_f32 v[24:25], v[24:25], s[58:59]
    v_pk_add_f32 v[26:27], v[26:27], s[58:59]
    v_pk_add_f32 v[28:29], v[28:29], s[58:59]
    v_pk_add_f32 v[30:31], v[30:31], s[58:59]
    v_pk_add_f32 v[32:33], v[32:33], s[58:59]
    v_pk_add_f32 v[34:35], v[34:35], s[58:59]
    v_rcp_f32 v24, v24
    v_rcp_f32 v25, v25
    v_rcp_f32 v26, v26
    v_rcp_f32 v27, v27
    v_rcp_f32 v28, v28
    v_rcp_f32 v29, v29
    v_rcp_f32 v30, v30
    v_rcp_f32 v31, v31
    v_rcp_f32 v32, v32
    v_rcp_f32 v33, v33
    v_rcp_f32 v34, v34
    v_rcp_f32 v35, v35
    v_pk_mul_f32 v[60:61], v[60:61], v[24:25]
    v_pk_mul_f32 v[62:63], v[62:63], v[26:27]
    v_pk_mul_f32 v[76:77], v[76:77], v[28:29]
    v_pk_mul_f32 v[78:79], v[78:79], v[30:31]
    v_pk_mul_f32 v[92:93], v[92:93], v[32:33]
    v_pk_mul_f32 v[94:95], v[94:95], v[34:35]
    v_cvt_pk_bf16_f32 v36, v60, v61
    v_cvt_pk_bf16_f32 v37, v62, v63
    ds_write_b64 v48, v[36:37] offset:36864
    v_cvt_pk_bf16_f32 v38, v76, v77
    v_cvt_pk_bf16_f32 v39, v78, v79
    ds_write_b64 v49, v[38:39] offset:36864
    v_cvt_pk_bf16_f32 v40, v92, v93
    v_cvt_pk_bf16_f32 v41, v94, v95
    ds_write_b64 v50, v[40:41] offset:36864
    v_mul_f32 v20, v167, v148
    v_mul_f32 v21, v167, v149
    v_mul_f32 v22, v167, v150
    v_mul_f32 v23, v167, v151
    v_fma_f32 v64, v64, v166, -v20
    v_fma_f32 v65, v65, v166, -v21
    v_fma_f32 v66, v66, v166, -v22
    v_fma_f32 v67, v67, v166, -v23
    v_mul_f32 v20, v167, v152
    v_mul_f32 v21, v167, v153
    v_mul_f32 v22, v167, v154
    v_mul_f32 v23, v167, v155
    v_fma_f32 v80, v80, v166, -v20
    v_fma_f32 v81, v81, v166, -v21
    v_fma_f32 v82, v82, v166, -v22
    v_fma_f32 v83, v83, v166, -v23
    v_mul_f32 v20, v167, v156
    v_mul_f32 v21, v167, v157
    v_mul_f32 v22, v167, v158
    v_mul_f32 v23, v167, v159
    v_fma_f32 v96, v96, v166, -v20
    v_fma_f32 v97, v97, v166, -v21
    v_fma_f32 v98, v98, v166, -v22
    v_fma_f32 v99, v99, v166, -v23
    v_pk_mul_f32 v[24:25], v[64:65], v[64:65]
    v_pk_mul_f32 v[26:27], v[66:67], v[66:67]
    v_pk_mul_f32 v[28:29], v[80:81], v[80:81]
    v_pk_mul_f32 v[30:31], v[82:83], v[82:83]
    v_pk_mul_f32 v[32:33], v[96:97], v[96:97]
    v_pk_mul_f32 v[34:35], v[98:99], v[98:99]
    v_pk_fma_f32 v[24:25], v[24:25], s[54:55], v[18:19]
    v_pk_fma_f32 v[26:27], v[26:27], s[54:55], v[18:19]
    v_pk_fma_f32 v[28:29], v[28:29], s[54:55], v[18:19]
    v_pk_fma_f32 v[30:31], v[30:31], s[54:55], v[18:19]
    v_pk_fma_f32 v[32:33], v[32:33], s[54:55], v[18:19]
    v_pk_fma_f32 v[34:35], v[34:35], s[54:55], v[18:19]
    v_pk_mul_f32 v[24:25], v[24:25], v[64:65]
    v_pk_mul_f32 v[26:27], v[26:27], v[66:67]
    v_pk_mul_f32 v[28:29], v[28:29], v[80:81]
    v_pk_mul_f32 v[30:31], v[30:31], v[82:83]
    v_pk_mul_f32 v[32:33], v[32:33], v[96:97]
    v_pk_mul_f32 v[34:35], v[34:35], v[98:99]
    v_exp_f32 v24, v24
    v_exp_f32 v25, v25
    v_exp_f32 v26, v26
    v_exp_f32 v27, v27
    v_exp_f32 v28, v28
    v_exp_f32 v29, v29
    v_exp_f32 v30, v30
    v_exp_f32 v31, v31
    v_exp_f32 v32, v32
    v_exp_f32 v33, v33
    v_exp_f32 v34, v34
    v_exp_f32 v35, v35
    v_pk_add_f32 v[24:25], v[24:25], s[58:59]
    v_pk_add_f32 v[26:27], v[26:27], s[58:59]
    v_pk_add_f32 v[28:29], v[28:29], s[58:59]
    v_pk_add_f32 v[30:31], v[30:31], s[58:59]
    v_pk_add_f32 v[32:33], v[32:33], s[58:59]
    v_pk_add_f32 v[34:35], v[34:35], s[58:59]
    v_rcp_f32 v24, v24
    v_rcp_f32 v25, v25
    v_rcp_f32 v26, v26
    v_rcp_f32 v27, v27
    v_rcp_f32 v28, v28
    v_rcp_f32 v29, v29
    v_rcp_f32 v30, v30
    v_rcp_f32 v31, v31
    v_rcp_f32 v32, v32
    v_rcp_f32 v33, v33
    v_rcp_f32 v34, v34
    v_rcp_f32 v35, v35
    v_pk_mul_f32 v[64:65], v[64:65], v[24:25]
    v_pk_mul_f32 v[66:67], v[66:67], v[26:27]
    v_pk_mul_f32 v[80:81], v[80:81], v[28:29]
    v_pk_mul_f32 v[82:83], v[82:83], v[30:31]
    v_pk_mul_f32 v[96:97], v[96:97], v[32:33]
    v_pk_mul_f32 v[98:99], v[98:99], v[34:35]
    v_cvt_pk_bf16_f32 v36, v64, v65
    v_cvt_pk_bf16_f32 v37, v66, v67
    ds_write_b64 v48, v[36:37] offset:55296
    v_cvt_pk_bf16_f32 v38, v80, v81
    v_cvt_pk_bf16_f32 v39, v82, v83
    ds_write_b64 v49, v[38:39] offset:55296
    v_cvt_pk_bf16_f32 v40, v96, v97
    v_cvt_pk_bf16_f32 v41, v98, v99
    ds_write_b64 v50, v[40:41] offset:55296
    s_waitcnt lgkmcnt(0)
    s_barrier
    v_and_b32 v12, 15, v1
    v_lshrrev_b32 v13, 4, v1
    v_and_b32 v14, 7, v12
    v_mul_u32_u24 v15, 1152, v12
    v_add_u32 v15, 73728, v15
    v_xor_b32 v16, v13, v14
    v_lshl_add_u32 v8, v16, 4, v15
    v_or_b32 v16, 4, v13
    v_xor_b32 v16, v16, v14
    v_lshl_add_u32 v9, v16, 4, v15
    v_mov_b32 v52, 0
    v_mov_b32 v53, 0
    v_mov_b32 v54, 0
    v_mov_b32 v55, 0
    v_mov_b32 v56, 0
    v_mov_b32 v57, 0
    v_mov_b32 v58, 0
    v_mov_b32 v59, 0
    v_mov_b32 v60, 0
    v_mov_b32 v61, 0
    v_mov_b32 v62, 0
    v_mov_b32 v63, 0
    v_mov_b32 v64, 0
    v_mov_b32 v65, 0
    v_mov_b32 v66, 0
    v_mov_b32 v67, 0
    v_mov_b32 v68, 0
    v_mov_b32 v69, 0
    v_mov_b32 v70, 0
    v_mov_b32 v71, 0
    v_mov_b32 v72, 0
    v_mov_b32 v73, 0
    v_mov_b32 v74, 0
    v_mov_b32 v75, 0
    v_mov_b32 v76, 0
    v_mov_b32 v77, 0
    v_mov_b32 v78, 0
    v_mov_b32 v79, 0
    v_mov_b32 v80, 0
    v_mov_b32 v81, 0
    v_mov_b32 v82, 0
    v_mov_b32 v83, 0
    v_mov_b32 v84, 0
    v_mov_b32 v85, 0
    v_mov_b32 v86, 0
    v_mov_b32 v87, 0
    v_mov_b32 v88, 0
    v_mov_b32 v89, 0
    v_mov_b32 v90, 0
    v_mov_b32 v91, 0
    v_mov_b32 v92, 0
    v_mov_b32 v93, 0
    v_mov_b32 v94, 0
    v_mov_b32 v95, 0
    v_mov_b32 v96, 0
    v_mov_b32 v97, 0
    v_mov_b32 v98, 0
    v_mov_b32 v99, 0
    ds_read_b128 v[20:23], v8 offset:0
    ds_read_b128 v[24:27], v8 offset:18432
    ds_read_b128 v[28:31], v8 offset:36864
    ds_read_b128 v[32:35], v8 offset:55296
    s_waitcnt vmcnt(9) lgkmcnt(0)
    v_mfma_f32_16x16x32_bf16 v[52:55], v[124:127], v[20:23], v[52:55]
    ds_read_b128 v[36:39], v9 offset:0
    v_mfma_f32_16x16x32_bf16 v[68:71], v[128:131], v[20:23], v[68:71]
    v_mfma_f32_16x16x32_bf16 v[84:87], v[132:135], v[20:23], v[84:87]
    ds_read_b128 v[40:43], v9 offset:18432
    v_mfma_f32_16x16x32_bf16 v[56:59], v[124:127], v[24:27], v[56:59]
    v_mfma_f32_16x16x32_bf16 v[72:75], v[128:131], v[24:27], v[72:75]
    ds_read_b128 v[44:47], v9 offset:36864
    v_mfma_f32_16x16x32_bf16 v[88:91], v[132:135], v[24:27], v[88:91]
    v_mfma_f32_16x16x32_bf16 v[60:63], v[124:127], v[28:31], v[60:63]
    ds_read_b128 v[48:51], v9 offset:55296
    v_mfma_f32_16x16x32_bf16 v[76:79], v[128:131], v[28:31], v[76:79]
    v_mfma_f32_16x16x32_bf16 v[92:95], v[132:135], v[28:31], v[92:95]
    v_mfma_f32_16x16x32_bf16 v[64:67], v[124:127], v[32:35], v[64:67]
    v_mfma_f32_16x16x32_bf16 v[80:83], v[128:131], v[32:35], v[80:83]
    v_mfma_f32_16x16x32_bf16 v[96:99], v[132:135], v[32:35], v[96:99]
    buffer_load_dwordx4 v[124:127], v3, s[16:19], s45 offen offset:0 sc1
    buffer_load_dwordx4 v[128:131], v3, s[16:19], s45 offen offset:1024 sc1
    buffer_load_dwordx4 v[132:135], v3, s[16:19], s45 offen offset:2048 sc1
    s_add_u32 s45, s45, 3072
    s_waitcnt vmcnt(9) lgkmcnt(0)
    v_mfma_f32_16x16x32_bf16 v[52:55], v[136:139], v[36:39], v[52:55]
    ds_read_b128 v[20:23], v8 offset:128
    v_mfma_f32_16x16x32_bf16 v[68:71], v[140:143], v[36:39], v[68:71]
    v_mfma_f32_16x16x32_bf16 v[84:87], v[144:147], v[36:39], v[84:87]
    ds_read_b128 v[24:27], v8 offset:18560
    v_mfma_f32_16x16x32_bf16 v[56:59], v[136:139], v[40:43], v[56:59]
    v_mfma_f32_16x16x32_bf16 v[72:75], v[140:143], v[40:43], v[72:75]
    ds_read_b128 v[28:31], v8 offset:36992
    v_mfma_f32_16x16x32_bf16 v[88:91], v[144:147], v[40:43], v[88:91]
    v_mfma_f32_16x16x32_bf16 v[60:63], v[136:139], v[44:47], v[60:63]
    ds_read_b128 v[32:35], v8 offset:55424
    v_mfma_f32_16x16x32_bf16 v[76:79], v[140:143], v[44:47], v[76:79]
    v_mfma_f32_16x16x32_bf16 v[92:95], v[144:147], v[44:47], v[92:95]
    v_mfma_f32_16x16x32_bf16 v[64:67], v[136:139], v[48:51], v[64:67]
    v_mfma_f32_16x16x32_bf16 v[80:83], v[140:143], v[48:51], v[80:83]
    v_mfma_f32_16x16x32_bf16 v[96:99], v[144:147], v[48:51], v[96:99]
    buffer_load_dwordx4 v[136:139], v3, s[16:19], s45 offen offset:0 sc1
    buffer_load_dwordx4 v[140:143], v3, s[16:19], s45 offen offset:1024 sc1
    buffer_load_dwordx4 v[144:147], v3, s[16:19], s45 offen offset:2048 sc1
    s_add_u32 s45, s45, 3072
    s_waitcnt vmcnt(9) lgkmcnt(0)
    v_mfma_f32_16x16x32_bf16 v[52:55], v[100:103], v[20:23], v[52:55]
    ds_read_b128 v[36:39], v9 offset:128
    v_mfma_f32_16x16x32_bf16 v[68:71], v[104:107], v[20:23], v[68:71]
    v_mfma_f32_16x16x32_bf16 v[84:87], v[108:111], v[20:23], v[84:87]
    ds_read_b128 v[40:43], v9 offset:18560
    v_mfma_f32_16x16x32_bf16 v[56:59], v[100:103], v[24:27], v[56:59]
    v_mfma_f32_16x16x32_bf16 v[72:75], v[104:107], v[24:27], v[72:75]
    ds_read_b128 v[44:47], v9 offset:36992
    v_mfma_f32_16x16x32_bf16 v[88:91], v[108:111], v[24:27], v[88:91]
    v_mfma_f32_16x16x32_bf16 v[60:63], v[100:103], v[28:31], v[60:63]
    ds_read_b128 v[48:51], v9 offset:55424
    v_mfma_f32_16x16x32_bf16 v[76:79], v[104:107], v[28:31], v[76:79]
    v_mfma_f32_16x16x32_bf16 v[92:95], v[108:111], v[28:31], v[92:95]
    v_mfma_f32_16x16x32_bf16 v[64:67], v[100:103], v[32:35], v[64:67]
    v_mfma_f32_16x16x32_bf16 v[80:83], v[104:107], v[32:35], v[80:83]
    v_mfma_f32_16x16x32_bf16 v[96:99], v[108:111], v[32:35], v[96:99]
    buffer_load_dwordx4 v[100:103], v3, s[16:19], s45 offen offset:0 sc1
    buffer_load_dwordx4 v[104:107], v3, s[16:19], s45 offen offset:1024 sc1
    buffer_load_dwordx4 v[108:111], v3, s[16:19], s45 offen offset:2048 sc1
    s_add_u32 s45, s45, 3072
    s_waitcnt vmcnt(9) lgkmcnt(0)
    v_mfma_f32_16x16x32_bf16 v[52:55], v[112:115], v[36:39], v[52:55]
    ds_read_b128 v[20:23], v8 offset:256
    v_mfma_f32_16x16x32_bf16 v[68:71], v[116:119], v[36:39], v[68:71]
    v_mfma_f32_16x16x32_bf16 v[84:87], v[120:123], v[36:39], v[84:87]
    ds_read_b128 v[24:27], v8 offset:18688
    v_mfma_f32_16x16x32_bf16 v[56:59], v[112:115], v[40:43], v[56:59]
    v_mfma_f32_16x16x32_bf16 v[72:75], v[116:119], v[40:43], v[72:75]
    ds_read_b128 v[28:31], v8 offset:37120
    v_mfma_f32_16x16x32_bf16 v[88:91], v[120:123], v[40:43], v[88:91]
    v_mfma_f32_16x16x32_bf16 v[60:63], v[112:115], v[44:47], v[60:63]
    ds_read_b128 v[32:35], v8 offset:55552
    v_mfma_f32_16x16x32_bf16 v[76:79], v[116:119], v[44:47], v[76:79]
    v_mfma_f32_16x16x32_bf16 v[92:95], v[120:123], v[44:47], v[92:95]
    v_mfma_f32_16x16x32_bf16 v[64:67], v[112:115], v[48:51], v[64:67]
    v_mfma_f32_16x16x32_bf16 v[80:83], v[116:119], v[48:51], v[80:83]
    v_mfma_f32_16x16x32_bf16 v[96:99], v[120:123], v[48:51], v[96:99]
    buffer_load_dwordx4 v[112:115], v3, s[16:19], s45 offen offset:0 sc1
    buffer_load_dwordx4 v[116:119], v3, s[16:19], s45 offen offset:1024 sc1
    buffer_load_dwordx4 v[120:123], v3, s[16:19], s45 offen offset:2048 sc1
    s_add_u32 s45, s45, 3072
    s_waitcnt vmcnt(9) lgkmcnt(0)
    v_mfma_f32_16x16x32_bf16 v[52:55], v[124:127], v[20:23], v[52:55]
    ds_read_b128 v[36:39], v9 offset:256
    v_mfma_f32_16x16x32_bf16 v[68:71], v[128:131], v[20:23], v[68:71]
    v_mfma_f32_16x16x32_bf16 v[84:87], v[132:135], v[20:23], v[84:87]
    ds_read_b128 v[40:43], v9 offset:18688
    v_mfma_f32_16x16x32_bf16 v[56:59], v[124:127], v[24:27], v[56:59]
    v_mfma_f32_16x16x32_bf16 v[72:75], v[128:131], v[24:27], v[72:75]
    ds_read_b128 v[44:47], v9 offset:37120
    v_mfma_f32_16x16x32_bf16 v[88:91], v[132:135], v[24:27], v[88:91]
    v_mfma_f32_16x16x32_bf16 v[60:63], v[124:127], v[28:31], v[60:63]
    ds_read_b128 v[48:51], v9 offset:55552
    v_mfma_f32_16x16x32_bf16 v[76:79], v[128:131], v[28:31], v[76:79]
    v_mfma_f32_16x16x32_bf16 v[92:95], v[132:135], v[28:31], v[92:95]
    v_mfma_f32_16x16x32_bf16 v[64:67], v[124:127], v[32:35], v[64:67]
    v_mfma_f32_16x16x32_bf16 v[80:83], v[128:131], v[32:35], v[80:83]
    v_mfma_f32_16x16x32_bf16 v[96:99], v[132:135], v[32:35], v[96:99]
    buffer_load_dwordx4 v[124:127], v3, s[16:19], s45 offen offset:0 sc1
    buffer_load_dwordx4 v[128:131], v3, s[16:19], s45 offen offset:1024 sc1
    buffer_load_dwordx4 v[132:135], v3, s[16:19], s45 offen offset:2048 sc1
    s_add_u32 s45, s45, 3072
    s_waitcnt vmcnt(9) lgkmcnt(0)
    v_mfma_f32_16x16x32_bf16 v[52:55], v[136:139], v[36:39], v[52:55]
    ds_read_b128 v[20:23], v8 offset:384
    v_mfma_f32_16x16x32_bf16 v[68:71], v[140:143], v[36:39], v[68:71]
    v_mfma_f32_16x16x32_bf16 v[84:87], v[144:147], v[36:39], v[84:87]
    ds_read_b128 v[24:27], v8 offset:18816
    v_mfma_f32_16x16x32_bf16 v[56:59], v[136:139], v[40:43], v[56:59]
    v_mfma_f32_16x16x32_bf16 v[72:75], v[140:143], v[40:43], v[72:75]
    ds_read_b128 v[28:31], v8 offset:37248
    v_mfma_f32_16x16x32_bf16 v[88:91], v[144:147], v[40:43], v[88:91]
    v_mfma_f32_16x16x32_bf16 v[60:63], v[136:139], v[44:47], v[60:63]
    ds_read_b128 v[32:35], v8 offset:55680
    v_mfma_f32_16x16x32_bf16 v[76:79], v[140:143], v[44:47], v[76:79]
    v_mfma_f32_16x16x32_bf16 v[92:95], v[144:147], v[44:47], v[92:95]
    v_mfma_f32_16x16x32_bf16 v[64:67], v[136:139], v[48:51], v[64:67]
    v_mfma_f32_16x16x32_bf16 v[80:83], v[140:143], v[48:51], v[80:83]
    v_mfma_f32_16x16x32_bf16 v[96:99], v[144:147], v[48:51], v[96:99]
    buffer_load_dwordx4 v[136:139], v3, s[16:19], s45 offen offset:0 sc1
    buffer_load_dwordx4 v[140:143], v3, s[16:19], s45 offen offset:1024 sc1
    buffer_load_dwordx4 v[144:147], v3, s[16:19], s45 offen offset:2048 sc1
    s_add_u32 s45, s45, 3072
    s_waitcnt vmcnt(9) lgkmcnt(0)
    v_mfma_f32_16x16x32_bf16 v[52:55], v[100:103], v[20:23], v[52:55]
    ds_read_b128 v[36:39], v9 offset:384
    v_mfma_f32_16x16x32_bf16 v[68:71], v[104:107], v[20:23], v[68:71]
    v_mfma_f32_16x16x32_bf16 v[84:87], v[108:111], v[20:23], v[84:87]
    ds_read_b128 v[40:43], v9 offset:18816
    v_mfma_f32_16x16x32_bf16 v[56:59], v[100:103], v[24:27], v[56:59]
    v_mfma_f32_16x16x32_bf16 v[72:75], v[104:107], v[24:27], v[72:75]
    ds_read_b128 v[44:47], v9 offset:37248
    v_mfma_f32_16x16x32_bf16 v[88:91], v[108:111], v[24:27], v[88:91]
    v_mfma_f32_16x16x32_bf16 v[60:63], v[100:103], v[28:31], v[60:63]
    ds_read_b128 v[48:51], v9 offset:55680
    v_mfma_f32_16x16x32_bf16 v[76:79], v[104:107], v[28:31], v[76:79]
    v_mfma_f32_16x16x32_bf16 v[92:95], v[108:111], v[28:31], v[92:95]
    v_mfma_f32_16x16x32_bf16 v[64:67], v[100:103], v[32:35], v[64:67]
    v_mfma_f32_16x16x32_bf16 v[80:83], v[104:107], v[32:35], v[80:83]
    v_mfma_f32_16x16x32_bf16 v[96:99], v[108:111], v[32:35], v[96:99]
    buffer_load_dwordx4 v[100:103], v3, s[16:19], s45 offen offset:0 sc1
    buffer_load_dwordx4 v[104:107], v3, s[16:19], s45 offen offset:1024 sc1
    buffer_load_dwordx4 v[108:111], v3, s[16:19], s45 offen offset:2048 sc1
    s_add_u32 s45, s45, 3072
    s_waitcnt vmcnt(9) lgkmcnt(0)
    v_mfma_f32_16x16x32_bf16 v[52:55], v[112:115], v[36:39], v[52:55]
    ds_read_b128 v[20:23], v8 offset:512
    v_mfma_f32_16x16x32_bf16 v[68:71], v[116:119], v[36:39], v[68:71]
    v_mfma_f32_16x16x32_bf16 v[84:87], v[120:123], v[36:39], v[84:87]
    ds_read_b128 v[24:27], v8 offset:18944
    v_mfma_f32_16x16x32_bf16 v[56:59], v[112:115], v[40:43], v[56:59]
    v_mfma_f32_16x16x32_bf16 v[72:75], v[116:119], v[40:43], v[72:75]
    ds_read_b128 v[28:31], v8 offset:37376
    v_mfma_f32_16x16x32_bf16 v[88:91], v[120:123], v[40:43], v[88:91]
    v_mfma_f32_16x16x32_bf16 v[60:63], v[112:115], v[44:47], v[60:63]
    ds_read_b128 v[32:35], v8 offset:55808
    v_mfma_f32_16x16x32_bf16 v[76:79], v[116:119], v[44:47], v[76:79]
    v_mfma_f32_16x16x32_bf16 v[92:95], v[120:123], v[44:47], v[92:95]
    v_mfma_f32_16x16x32_bf16 v[64:67], v[112:115], v[48:51], v[64:67]
    v_mfma_f32_16x16x32_bf16 v[80:83], v[116:119], v[48:51], v[80:83]
    v_mfma_f32_16x16x32_bf16 v[96:99], v[120:123], v[48:51], v[96:99]
    buffer_load_dwordx4 v[112:115], v3, s[16:19], s45 offen offset:0 sc1
    buffer_load_dwordx4 v[116:119], v3, s[16:19], s45 offen offset:1024 sc1
    buffer_load_dwordx4 v[120:123], v3, s[16:19], s45 offen offset:2048 sc1
    s_add_u32 s45, s45, 3072
    s_waitcnt vmcnt(9) lgkmcnt(0)
    v_mfma_f32_16x16x32_bf16 v[52:55], v[124:127], v[20:23], v[52:55]
    ds_read_b128 v[36:39], v9 offset:512
    v_mfma_f32_16x16x32_bf16 v[68:71], v[128:131], v[20:23], v[68:71]
    v_mfma_f32_16x16x32_bf16 v[84:87], v[132:135], v[20:23], v[84:87]
    ds_read_b128 v[40:43], v9 offset:18944
    v_mfma_f32_16x16x32_bf16 v[56:59], v[124:127], v[24:27], v[56:59]
    v_mfma_f32_16x16x32_bf16 v[72:75], v[128:131], v[24:27], v[72:75]
    ds_read_b128 v[44:47], v9 offset:37376
    v_mfma_f32_16x16x32_bf16 v[88:91], v[132:135], v[24:27], v[88:91]
    v_mfma_f32_16x16x32_bf16 v[60:63], v[124:127], v[28:31], v[60:63]
    ds_read_b128 v[48:51], v9 offset:55808
    v_mfma_f32_16x16x32_bf16 v[76:79], v[128:131], v[28:31], v[76:79]
    v_mfma_f32_16x16x32_bf16 v[92:95], v[132:135], v[28:31], v[92:95]
    v_mfma_f32_16x16x32_bf16 v[64:67], v[124:127], v[32:35], v[64:67]
    v_mfma_f32_16x16x32_bf16 v[80:83], v[128:131], v[32:35], v[80:83]
    v_mfma_f32_16x16x32_bf16 v[96:99], v[132:135], v[32:35], v[96:99]
    buffer_load_dwordx4 v[124:127], v3, s[16:19], s45 offen offset:0 sc1
    buffer_load_dwordx4 v[128:131], v3, s[16:19], s45 offen offset:1024 sc1
    buffer_load_dwordx4 v[132:135], v3, s[16:19], s45 offen offset:2048 sc1
    s_add_u32 s45, s45, 3072
    s_waitcnt vmcnt(9) lgkmcnt(0)
    v_mfma_f32_16x16x32_bf16 v[52:55], v[136:139], v[36:39], v[52:55]
    ds_read_b128 v[20:23], v8 offset:640
    v_mfma_f32_16x16x32_bf16 v[68:71], v[140:143], v[36:39], v[68:71]
    v_mfma_f32_16x16x32_bf16 v[84:87], v[144:147], v[36:39], v[84:87]
    ds_read_b128 v[24:27], v8 offset:19072
    v_mfma_f32_16x16x32_bf16 v[56:59], v[136:139], v[40:43], v[56:59]
    v_mfma_f32_16x16x32_bf16 v[72:75], v[140:143], v[40:43], v[72:75]
    ds_read_b128 v[28:31], v8 offset:37504
    v_mfma_f32_16x16x32_bf16 v[88:91], v[144:147], v[40:43], v[88:91]
    v_mfma_f32_16x16x32_bf16 v[60:63], v[136:139], v[44:47], v[60:63]
    ds_read_b128 v[32:35], v8 offset:55936
    v_mfma_f32_16x16x32_bf16 v[76:79], v[140:143], v[44:47], v[76:79]
    v_mfma_f32_16x16x32_bf16 v[92:95], v[144:147], v[44:47], v[92:95]
    v_mfma_f32_16x16x32_bf16 v[64:67], v[136:139], v[48:51], v[64:67]
    v_mfma_f32_16x16x32_bf16 v[80:83], v[140:143], v[48:51], v[80:83]
    v_mfma_f32_16x16x32_bf16 v[96:99], v[144:147], v[48:51], v[96:99]
    buffer_load_dwordx4 v[136:139], v3, s[16:19], s45 offen offset:0 sc1
    buffer_load_dwordx4 v[140:143], v3, s[16:19], s45 offen offset:1024 sc1
    buffer_load_dwordx4 v[144:147], v3, s[16:19], s45 offen offset:2048 sc1
    s_add_u32 s45, s45, 3072
    s_waitcnt vmcnt(9) lgkmcnt(0)
    v_mfma_f32_16x16x32_bf16 v[52:55], v[100:103], v[20:23], v[52:55]
    ds_read_b128 v[36:39], v9 offset:640
    v_mfma_f32_16x16x32_bf16 v[68:71], v[104:107], v[20:23], v[68:71]
    v_mfma_f32_16x16x32_bf16 v[84:87], v[108:111], v[20:23], v[84:87]
    ds_read_b128 v[40:43], v9 offset:19072
    v_mfma_f32_16x16x32_bf16 v[56:59], v[100:103], v[24:27], v[56:59]
    v_mfma_f32_16x16x32_bf16 v[72:75], v[104:107], v[24:27], v[72:75]
    ds_read_b128 v[44:47], v9 offset:37504
    v_mfma_f32_16x16x32_bf16 v[88:91], v[108:111], v[24:27], v[88:91]
    v_mfma_f32_16x16x32_bf16 v[60:63], v[100:103], v[28:31], v[60:63]
    ds_read_b128 v[48:51], v9 offset:55936
    v_mfma_f32_16x16x32_bf16 v[76:79], v[104:107], v[28:31], v[76:79]
    v_mfma_f32_16x16x32_bf16 v[92:95], v[108:111], v[28:31], v[92:95]
    v_mfma_f32_16x16x32_bf16 v[64:67], v[100:103], v[32:35], v[64:67]
    v_mfma_f32_16x16x32_bf16 v[80:83], v[104:107], v[32:35], v[80:83]
    v_mfma_f32_16x16x32_bf16 v[96:99], v[108:111], v[32:35], v[96:99]
    buffer_load_dwordx4 v[100:103], v3, s[16:19], s45 offen offset:0 sc1
    buffer_load_dwordx4 v[104:107], v3, s[16:19], s45 offen offset:1024 sc1
    buffer_load_dwordx4 v[108:111], v3, s[16:19], s45 offen offset:2048 sc1
    s_add_u32 s45, s45, 3072
    s_waitcnt vmcnt(9) lgkmcnt(0)
    v_mfma_f32_16x16x32_bf16 v[52:55], v[112:115], v[36:39], v[52:55]
    ds_read_b128 v[20:23], v8 offset:768
    v_mfma_f32_16x16x32_bf16 v[68:71], v[116:119], v[36:39], v[68:71]
    v_mfma_f32_16x16x32_bf16 v[84:87], v[120:123], v[36:39], v[84:87]
    ds_read_b128 v[24:27], v8 offset:19200
    v_mfma_f32_16x16x32_bf16 v[56:59], v[112:115], v[40:43], v[56:59]
    v_mfma_f32_16x16x32_bf16 v[72:75], v[116:119], v[40:43], v[72:75]
    ds_read_b128 v[28:31], v8 offset:37632
    v_mfma_f32_16x16x32_bf16 v[88:91], v[120:123], v[40:43], v[88:91]
    v_mfma_f32_16x16x32_bf16 v[60:63], v[112:115], v[44:47], v[60:63]
    ds_read_b128 v[32:35], v8 offset:56064
    v_mfma_f32_16x16x32_bf16 v[76:79], v[116:119], v[44:47], v[76:79]
    v_mfma_f32_16x16x32_bf16 v[92:95], v[120:123], v[44:47], v[92:95]
    v_mfma_f32_16x16x32_bf16 v[64:67], v[112:115], v[48:51], v[64:67]
    v_mfma_f32_16x16x32_bf16 v[80:83], v[116:119], v[48:51], v[80:83]
    v_mfma_f32_16x16x32_bf16 v[96:99], v[120:123], v[48:51], v[96:99]
    buffer_load_dwordx4 v[112:115], v3, s[16:19], s45 offen offset:0 sc1
    buffer_load_dwordx4 v[116:119], v3, s[16:19], s45 offen offset:1024 sc1
    buffer_load_dwordx4 v[120:123], v3, s[16:19], s45 offen offset:2048 sc1
    s_add_u32 s45, s45, 3072
    s_waitcnt vmcnt(9) lgkmcnt(0)
    v_mfma_f32_16x16x32_bf16 v[52:55], v[124:127], v[20:23], v[52:55]
    ds_read_b128 v[36:39], v9 offset:768
    v_mfma_f32_16x16x32_bf16 v[68:71], v[128:131], v[20:23], v[68:71]
    v_mfma_f32_16x16x32_bf16 v[84:87], v[132:135], v[20:23], v[84:87]
    ds_read_b128 v[40:43], v9 offset:19200
    v_mfma_f32_16x16x32_bf16 v[56:59], v[124:127], v[24:27], v[56:59]
    v_mfma_f32_16x16x32_bf16 v[72:75], v[128:131], v[24:27], v[72:75]
    ds_read_b128 v[44:47], v9 offset:37632
    v_mfma_f32_16x16x32_bf16 v[88:91], v[132:135], v[24:27], v[88:91]
    v_mfma_f32_16x16x32_bf16 v[60:63], v[124:127], v[28:31], v[60:63]
    ds_read_b128 v[48:51], v9 offset:56064
    v_mfma_f32_16x16x32_bf16 v[76:79], v[128:131], v[28:31], v[76:79]
    v_mfma_f32_16x16x32_bf16 v[92:95], v[132:135], v[28:31], v[92:95]
    v_mfma_f32_16x16x32_bf16 v[64:67], v[124:127], v[32:35], v[64:67]
    v_mfma_f32_16x16x32_bf16 v[80:83], v[128:131], v[32:35], v[80:83]
    v_mfma_f32_16x16x32_bf16 v[96:99], v[132:135], v[32:35], v[96:99]
    buffer_load_dwordx4 v[124:127], v3, s[16:19], s45 offen offset:0 sc1
    buffer_load_dwordx4 v[128:131], v3, s[16:19], s45 offen offset:1024 sc1
    buffer_load_dwordx4 v[132:135], v3, s[16:19], s45 offen offset:2048 sc1
    s_add_u32 s45, s45, 3072
    s_waitcnt vmcnt(9) lgkmcnt(0)
    v_mfma_f32_16x16x32_bf16 v[52:55], v[136:139], v[36:39], v[52:55]
    ds_read_b128 v[20:23], v8 offset:896
    v_mfma_f32_16x16x32_bf16 v[68:71], v[140:143], v[36:39], v[68:71]
    v_mfma_f32_16x16x32_bf16 v[84:87], v[144:147], v[36:39], v[84:87]
    ds_read_b128 v[24:27], v8 offset:19328
    v_mfma_f32_16x16x32_bf16 v[56:59], v[136:139], v[40:43], v[56:59]
    v_mfma_f32_16x16x32_bf16 v[72:75], v[140:143], v[40:43], v[72:75]
    ds_read_b128 v[28:31], v8 offset:37760
    v_mfma_f32_16x16x32_bf16 v[88:91], v[144:147], v[40:43], v[88:91]
    v_mfma_f32_16x16x32_bf16 v[60:63], v[136:139], v[44:47], v[60:63]
    ds_read_b128 v[32:35], v8 offset:56192
    v_mfma_f32_16x16x32_bf16 v[76:79], v[140:143], v[44:47], v[76:79]
    v_mfma_f32_16x16x32_bf16 v[92:95], v[144:147], v[44:47], v[92:95]
    v_mfma_f32_16x16x32_bf16 v[64:67], v[136:139], v[48:51], v[64:67]
    v_mfma_f32_16x16x32_bf16 v[80:83], v[140:143], v[48:51], v[80:83]
    v_mfma_f32_16x16x32_bf16 v[96:99], v[144:147], v[48:51], v[96:99]
    buffer_load_dwordx4 v[136:139], v3, s[16:19], s45 offen offset:0 sc1
    buffer_load_dwordx4 v[140:143], v3, s[16:19], s45 offen offset:1024 sc1
    buffer_load_dwordx4 v[144:147], v3, s[16:19], s45 offen offset:2048 sc1
    s_add_u32 s45, s45, 3072
    s_waitcnt vmcnt(9) lgkmcnt(0)
    v_mfma_f32_16x16x32_bf16 v[52:55], v[100:103], v[20:23], v[52:55]
    ds_read_b128 v[36:39], v9 offset:896
    v_mfma_f32_16x16x32_bf16 v[68:71], v[104:107], v[20:23], v[68:71]
    v_mfma_f32_16x16x32_bf16 v[84:87], v[108:111], v[20:23], v[84:87]
    ds_read_b128 v[40:43], v9 offset:19328
    v_mfma_f32_16x16x32_bf16 v[56:59], v[100:103], v[24:27], v[56:59]
    v_mfma_f32_16x16x32_bf16 v[72:75], v[104:107], v[24:27], v[72:75]
    ds_read_b128 v[44:47], v9 offset:37760
    v_mfma_f32_16x16x32_bf16 v[88:91], v[108:111], v[24:27], v[88:91]
    v_mfma_f32_16x16x32_bf16 v[60:63], v[100:103], v[28:31], v[60:63]
    ds_read_b128 v[48:51], v9 offset:56192
    v_mfma_f32_16x16x32_bf16 v[76:79], v[104:107], v[28:31], v[76:79]
    v_mfma_f32_16x16x32_bf16 v[92:95], v[108:111], v[28:31], v[92:95]
    v_mfma_f32_16x16x32_bf16 v[64:67], v[100:103], v[32:35], v[64:67]
    v_mfma_f32_16x16x32_bf16 v[80:83], v[104:107], v[32:35], v[80:83]
    v_mfma_f32_16x16x32_bf16 v[96:99], v[108:111], v[32:35], v[96:99]
    s_waitcnt vmcnt(6) lgkmcnt(0)
    v_mfma_f32_16x16x32_bf16 v[52:55], v[112:115], v[36:39], v[52:55]
    ds_read_b128 v[20:23], v8 offset:1024
    v_mfma_f32_16x16x32_bf16 v[68:71], v[116:119], v[36:39], v[68:71]
    v_mfma_f32_16x16x32_bf16 v[84:87], v[120:123], v[36:39], v[84:87]
    ds_read_b128 v[24:27], v8 offset:19456
    v_mfma_f32_16x16x32_bf16 v[56:59], v[112:115], v[40:43], v[56:59]
    v_mfma_f32_16x16x32_bf16 v[72:75], v[116:119], v[40:43], v[72:75]
    ds_read_b128 v[28:31], v8 offset:37888
    v_mfma_f32_16x16x32_bf16 v[88:91], v[120:123], v[40:43], v[88:91]
    v_mfma_f32_16x16x32_bf16 v[60:63], v[112:115], v[44:47], v[60:63]
    ds_read_b128 v[32:35], v8 offset:56320
    v_mfma_f32_16x16x32_bf16 v[76:79], v[116:119], v[44:47], v[76:79]
    v_mfma_f32_16x16x32_bf16 v[92:95], v[120:123], v[44:47], v[92:95]
    v_mfma_f32_16x16x32_bf16 v[64:67], v[112:115], v[48:51], v[64:67]
    v_mfma_f32_16x16x32_bf16 v[80:83], v[116:119], v[48:51], v[80:83]
    v_mfma_f32_16x16x32_bf16 v[96:99], v[120:123], v[48:51], v[96:99]
    s_waitcnt vmcnt(3) lgkmcnt(0)
    v_mfma_f32_16x16x32_bf16 v[52:55], v[124:127], v[20:23], v[52:55]
    ds_read_b128 v[36:39], v9 offset:1024
    v_mfma_f32_16x16x32_bf16 v[68:71], v[128:131], v[20:23], v[68:71]
    v_mfma_f32_16x16x32_bf16 v[84:87], v[132:135], v[20:23], v[84:87]
    ds_read_b128 v[40:43], v9 offset:19456
    v_mfma_f32_16x16x32_bf16 v[56:59], v[124:127], v[24:27], v[56:59]
    v_mfma_f32_16x16x32_bf16 v[72:75], v[128:131], v[24:27], v[72:75]
    ds_read_b128 v[44:47], v9 offset:37888
    v_mfma_f32_16x16x32_bf16 v[88:91], v[132:135], v[24:27], v[88:91]
    v_mfma_f32_16x16x32_bf16 v[60:63], v[124:127], v[28:31], v[60:63]
    ds_read_b128 v[48:51], v9 offset:56320
    v_mfma_f32_16x16x32_bf16 v[76:79], v[128:131], v[28:31], v[76:79]
    v_mfma_f32_16x16x32_bf16 v[92:95], v[132:135], v[28:31], v[92:95]
    v_mfma_f32_16x16x32_bf16 v[64:67], v[124:127], v[32:35], v[64:67]
    v_mfma_f32_16x16x32_bf16 v[80:83], v[128:131], v[32:35], v[80:83]
    v_mfma_f32_16x16x32_bf16 v[96:99], v[132:135], v[32:35], v[96:99]
    s_waitcnt vmcnt(0) lgkmcnt(0)
    v_mfma_f32_16x16x32_bf16 v[52:55], v[136:139], v[36:39], v[52:55]
    v_mfma_f32_16x16x32_bf16 v[68:71], v[140:143], v[36:39], v[68:71]
    v_mfma_f32_16x16x32_bf16 v[84:87], v[144:147], v[36:39], v[84:87]
    v_mfma_f32_16x16x32_bf16 v[56:59], v[136:139], v[40:43], v[56:59]
    v_mfma_f32_16x16x32_bf16 v[72:75], v[140:143], v[40:43], v[72:75]
    v_mfma_f32_16x16x32_bf16 v[88:91], v[144:147], v[40:43], v[88:91]
    v_mfma_f32_16x16x32_bf16 v[60:63], v[136:139], v[44:47], v[60:63]
    v_mfma_f32_16x16x32_bf16 v[76:79], v[140:143], v[44:47], v[76:79]
    v_mfma_f32_16x16x32_bf16 v[92:95], v[144:147], v[44:47], v[92:95]
    v_mfma_f32_16x16x32_bf16 v[64:67], v[136:139], v[48:51], v[64:67]
    v_mfma_f32_16x16x32_bf16 v[80:83], v[140:143], v[48:51], v[80:83]
    v_mfma_f32_16x16x32_bf16 v[96:99], v[144:147], v[48:51], v[96:99]
    v_and_b32 v12, 15, v1
    v_lshrrev_b32 v13, 4, v1
    v_lshrrev_b32 v14, 1, v13
    s_mul_i32 s31, s3, 6
    v_add_u32 v14, s31, v14
    v_and_b32 v15, 7, v12
    v_mul_u32_u24 v16, 1152, v12
    v_and_b32 v13, 1, v13
    v_lshl_add_u32 v16, v13, 3, v16
    v_add_u32 v13, 0, v14
    v_xor_b32 v13, v13, v15
    v_lshl_add_u32 v48, v13, 4, v16
    v_add_u32 v13, 2, v14
    v_xor_b32 v13, v13, v15
    v_lshl_add_u32 v49, v13, 4, v16
    v_add_u32 v13, 4, v14
    v_xor_b32 v13, v13, v15
    v_lshl_add_u32 v50, v13, 4, v16
    v_cvt_pk_bf16_f32 v20, v52, v53
    v_cvt_pk_bf16_f32 v21, v54, v55
    ds_write_b64 v48, v[20:21] offset:0
    v_cvt_pk_bf16_f32 v22, v68, v69
    v_cvt_pk_bf16_f32 v23, v70, v71
    ds_write_b64 v49, v[22:23] offset:0
    v_cvt_pk_bf16_f32 v24, v84, v85
    v_cvt_pk_bf16_f32 v25, v86, v87
    ds_write_b64 v50, v[24:25] offset:0
    v_cvt_pk_bf16_f32 v26, v56, v57
    v_cvt_pk_bf16_f32 v27, v58, v59
    ds_write_b64 v48, v[26:27] offset:18432
    v_cvt_pk_bf16_f32 v28, v72, v73
    v_cvt_pk_bf16_f32 v29, v74, v75
    ds_write_b64 v49, v[28:29] offset:18432
    v_cvt_pk_bf16_f32 v30, v88, v89
    v_cvt_pk_bf16_f32 v31, v90, v91
    ds_write_b64 v50, v[30:31] offset:18432
    v_cvt_pk_bf16_f32 v32, v60, v61
    v_cvt_pk_bf16_f32 v33, v62, v63
    ds_write_b64 v48, v[32:33] offset:36864
    v_cvt_pk_bf16_f32 v34, v76, v77
    v_cvt_pk_bf16_f32 v35, v78, v79
    ds_write_b64 v49, v[34:35] offset:36864
    v_cvt_pk_bf16_f32 v20, v92, v93
    v_cvt_pk_bf16_f32 v21, v94, v95
    ds_write_b64 v50, v[20:21] offset:36864
    v_cvt_pk_bf16_f32 v22, v64, v65
    v_cvt_pk_bf16_f32 v23, v66, v67
    ds_write_b64 v48, v[22:23] offset:55296
    v_cvt_pk_bf16_f32 v24, v80, v81
    v_cvt_pk_bf16_f32 v25, v82, v83
    ds_write_b64 v49, v[24:25] offset:55296
    v_cvt_pk_bf16_f32 v26, v96, v97
    v_cvt_pk_bf16_f32 v27, v98, v99
    ds_write_b64 v50, v[26:27] offset:55296
    s_waitcnt lgkmcnt(0)
    s_barrier
    v_lshlrev_b32 v12, 4, v0
    ds_read_b128 v[20:23], v12 offset:0
    ds_read_b128 v[24:27], v12 offset:12288
    ds_read_b128 v[28:31], v12 offset:24576
    ds_read_b128 v[32:35], v12 offset:36864
    ds_read_b128 v[36:39], v12 offset:49152
    ds_read_b128 v[40:43], v12 offset:61440
    v_add_u32 v13, 0, v0
    v_mul_u32_u24 v14, 58255, v13
    v_lshrrev_b32 v14, 22, v14
    v_mul_u32_u24 v15, 72, v14
    v_sub_u32 v15, v13, v15
    v_and_b32 v16, 7, v14
    v_xor_b32 v15, v15, v16
    v_mul_u32_u24 v14, 1152, v14
    v_lshl_add_u32 v52, v15, 4, v14
    v_add_u32 v13, 768, v0
    v_mul_u32_u24 v14, 58255, v13
    v_lshrrev_b32 v14, 22, v14
    v_mul_u32_u24 v15, 72, v14
    v_sub_u32 v15, v13, v15
    v_and_b32 v16, 7, v14
    v_xor_b32 v15, v15, v16
    v_mul_u32_u24 v14, 1152, v14
    v_lshl_add_u32 v53, v15, 4, v14
    v_add_u32 v13, 1536, v0
    v_mul_u32_u24 v14, 58255, v13
    v_lshrrev_b32 v14, 22, v14
    v_mul_u32_u24 v15, 72, v14
    v_sub_u32 v15, v13, v15
    v_and_b32 v16, 7, v14
    v_xor_b32 v15, v15, v16
    v_mul_u32_u24 v14, 1152, v14
    v_lshl_add_u32 v54, v15, 4, v14
    v_add_u32 v13, 2304, v0
    v_mul_u32_u24 v14, 58255, v13
    v_lshrrev_b32 v14, 22, v14
    v_mul_u32_u24 v15, 72, v14
    v_sub_u32 v15, v13, v15
    v_and_b32 v16, 7, v14
    v_xor_b32 v15, v15, v16
    v_mul_u32_u24 v14, 1152, v14
    v_lshl_add_u32 v55, v15, 4, v14
    v_add_u32 v13, 3072, v0
    v_mul_u32_u24 v14, 58255, v13
    v_lshrrev_b32 v14, 22, v14
    v_mul_u32_u24 v15, 72, v14
    v_sub_u32 v15, v13, v15
    v_and_b32 v16, 7, v14
    v_xor_b32 v15, v15, v16
    v_mul_u32_u24 v14, 1152, v14
    v_lshl_add_u32 v56, v15, 4, v14
    v_add_u32 v13, 3840, v0
    v_mul_u32_u24 v14, 58255, v13
    v_lshrrev_b32 v14, 22, v14
    v_mul_u32_u24 v15, 72, v14
    v_sub_u32 v15, v13, v15
    v_and_b32 v16, 7, v14
    v_xor_b32 v15, v15, v16
    v_mul_u32_u24 v14, 1152, v14
    v_lshl_add_u32 v57, v15, 4, v14
    s_mul_i32 s31, s61, 2359296
    s_mul_i32 s32, s62, 73728
    s_add_u32 s31, s31, s32
    s_add_u32 s31, s31, 0x1c00000
    s_waitcnt lgkmcnt(5)
    buffer_store_dwordx4 v[20:23], v52, s[16:19], s31 offen sc1
    s_waitcnt lgkmcnt(4)
    buffer_store_dwordx4 v[24:27], v53, s[16:19], s31 offen sc1
    s_waitcnt lgkmcnt(3)
    buffer_store_dwordx4 v[28:31], v54, s[16:19], s31 offen sc1
    s_waitcnt lgkmcnt(2)
    buffer_store_dwordx4 v[32:35], v55, s[16:19], s31 offen sc1
    s_waitcnt lgkmcnt(1)
    buffer_store_dwordx4 v[36:39], v56, s[16:19], s31 offen sc1
    s_waitcnt lgkmcnt(0)
    buffer_store_dwordx4 v[40:43], v57, s[16:19], s31 offen sc1
    s_waitcnt vmcnt(0)
    s_barrier
    s_cmp_eq_u32 s3, 11
    s_cbranch_scc0 L_m_nf
    s_lshl_b32 s31, s62, 3
    s_add_u32 s31, s31, s61
    s_lshl_b32 s31, s31, 7
    s_mov_b64 exec, 1
    v_mov_b32 v12, s28
    v_mov_b32 v13, 0x28000
    buffer_store_dword v12, v13, s[16:19], s31 offen sc1
    s_mov_b64 exec, -1
    s_lshl_b32 s31, s62, 10
    s_add_u32 s31, s31, 0x28000
    v_lshlrev_b32 v12, 7, v1
    v_add_u32 v12, s31, v12
    s_mov_b32 exec_lo, 0xff
    s_mov_b32 exec_hi, 0x0
    s_mov_b32 s72, 0x40000
Lpoll_43:
    buffer_load_dword v13, v12, s[16:19], 0 offen sc1
    s_waitcnt vmcnt(0)
    v_cmp_ne_u32 vcc, s28, v13
    s_cbranch_vccz Lpolld_44
    s_sub_u32 s72, s72, 1
    s_cbranch_scc1 Lpolld_44
    s_sleep 2
    s_branch Lpoll_43
Lpolld_44:
    s_mov_b64 exec, -1
L_m_nf:
    s_barrier
    s_cmp_ge_u32 s3, 9
    s_cbranch_scc1 Lfrd_45
    v_mul_u32_u24 v12, 911, v0
    v_lshrrev_b32 v12, 16, v12
    v_mul_u32_u24 v13, 72, v12
    v_sub_u32 v13, v0, v13
    v_lshlrev_b32 v14, 4, v0
    v_mul_u32_u24 v15, 57, v13
    v_lshrrev_b32 v15, 10, v15
    v_mul_u32_u24 v16, 18, v15
    v_sub_u32 v16, v13, v16
    v_mul_u32_u24 v12, 288, v12
    v_lshl_add_u32 v12, v16, 4, v12
    s_mov_b32 s31, 589824
    v_mul_lo_u32 v15, v15, s31
    v_add_u32 v15, v15, v12
    s_lshl_b32 s32, s62, 6
    s_lshl_b32 s33, s61, 3
    s_add_u32 s32, s32, s33
    s_mul_i32 s33, s32, 1152
    s_mul_i32 s34, s32, 288
    s_add_u32 s35, s33, 0x1c00000
    buffer_load_dwordx4 v[20:23], v14, s[16:19], s35 offen sc1
    s_add_u32 s35, s35, 2359296
    buffer_load_dwordx4 v[24:27], v14, s[16:19], s35 offen sc1
    s_add_u32 s35, s35, 2359296
    buffer_load_dwordx4 v[28:31], v14, s[16:19], s35 offen sc1
    s_add_u32 s35, s35, 2359296
    buffer_load_dwordx4 v[32:35], v14, s[16:19], s35 offen sc1
    s_add_u32 s35, s35, 2359296
    buffer_load_dwordx4 v[36:39], v14, s[16:19], s35 offen sc1
    s_add_u32 s35, s35, 2359296
    buffer_load_dwordx4 v[40:43], v14, s[16:19], s35 offen sc1
    s_add_u32 s35, s35, 2359296
    buffer_load_dwordx4 v[44:47], v14, s[16:19], s35 offen sc1
    s_add_u32 s35, s35, 2359296
    buffer_load_dwordx4 v[48:51], v14, s[16:19], s35 offen sc1
    s_add_u32 s35, s34, 0x340000
    buffer_load_dwordx4 v[52:55], v15, s[16:19], s35 offen sc1
    s_add_u32 s35, s34, 0x7c0000
    buffer_load_dwordx4 v[56:59], v15, s[16:19], s35 offen sc1
    s_waitcnt vmcnt(2)
    v_lshlrev_b32 v60, 16, v20
    v_and_b32 v61, 0xffff0000, v20
    v_lshlrev_b32 v62, 16, v21
    v_and_b32 v63, 0xffff0000, v21
    v_lshlrev_b32 v64, 16, v22
    v_and_b32 v65, 0xffff0000, v22
    v_lshlrev_b32 v66, 16, v23
    v_and_b32 v67, 0xffff0000, v23
    v_lshlrev_b32 v68, 16, v24
    v_and_b32 v69, 0xffff0000, v24
    v_pk_add_f32 v[60:61], v[60:61], v[68:69]
    v_lshlrev_b32 v68, 16, v25
    v_and_b32 v69, 0xffff0000, v25
    v_pk_add_f32 v[62:63], v[62:63], v[68:69]
    v_lshlrev_b32 v68, 16, v26
    v_and_b32 v69, 0xffff0000, v26
    v_pk_add_f32 v[64:65], v[64:65], v[68:69]
    v_lshlrev_b32 v68, 16, v27
    v_and_b32 v69, 0xffff0000, v27
    v_pk_add_f32 v[66:67], v[66:67], v[68:69]
    v_lshlrev_b32 v68, 16, v28
    v_and_b32 v69, 0xffff0000, v28
    v_pk_add_f32 v[60:61], v[60:61], v[68:69]
    v_lshlrev_b32 v68, 16, v29
    v_and_b32 v69, 0xffff0000, v29
    v_pk_add_f32 v[62:63], v[62:63], v[68:69]
    v_lshlrev_b32 v68, 16, v30
    v_and_b32 v69, 0xffff0000, v30
    v_pk_add_f32 v[64:65], v[64:65], v[68:69]
    v_lshlrev_b32 v68, 16, v31
    v_and_b32 v69, 0xffff0000, v31
    v_pk_add_f32 v[66:67], v[66:67], v[68:69]
    v_lshlrev_b32 v68, 16, v32
    v_and_b32 v69, 0xffff0000, v32
    v_pk_add_f32 v[60:61], v[60:61], v[68:69]
    v_lshlrev_b32 v68, 16, v33
    v_and_b32 v69, 0xffff0000, v33
    v_pk_add_f32 v[62:63], v[62:63], v[68:69]
    v_lshlrev_b32 v68, 16, v34
    v_and_b32 v69, 0xffff0000, v34
    v_pk_add_f32 v[64:65], v[64:65], v[68:69]
    v_lshlrev_b32 v68, 16, v35
    v_and_b32 v69, 0xffff0000, v35
    v_pk_add_f32 v[66:67], v[66:67], v[68:69]
    v_lshlrev_b32 v68, 16, v36
    v_and_b32 v69, 0xffff0000, v36
    v_pk_add_f32 v[60:61], v[60:61], v[68:69]
    v_lshlrev_b32 v68, 16, v37
    v_and_b32 v69, 0xffff0000, v37
    v_pk_add_f32 v[62:63], v[62:63], v[68:69]
    v_lshlrev_b32 v68, 16, v38
    v_and_b32 v69, 0xffff0000, v38
    v_pk_add_f32 v[64:65], v[64:65], v[68:69]
    v_lshlrev_b32 v68, 16, v39
    v_and_b32 v69, 0xffff0000, v39
    v_pk_add_f32 v[66:67], v[66:67], v[68:69]
    v_lshlrev_b32 v68, 16, v40
    v_and_b32 v69, 0xffff0000, v40
    v_pk_add_f32 v[60:61], v[60:61], v[68:69]
    v_lshlrev_b32 v68, 16, v41
    v_and_b32 v69, 0xffff0000, v41
    v_pk_add_f32 v[62:63], v[62:63], v[68:69]
    v_lshlrev_b32 v68, 16, v42
    v_and_b32 v69, 0xffff0000, v42
    v_pk_add_f32 v[64:65], v[64:65], v[68:69]
    v_lshlrev_b32 v68, 16, v43
    v_and_b32 v69, 0xffff0000, v43
    v_pk_add_f32 v[66:67], v[66:67], v[68:69]
    v_lshlrev_b32 v68, 16, v44
    v_and_b32 v69, 0xffff0000, v44
    v_pk_add_f32 v[60:61], v[60:61], v[68:69]
    v_lshlrev_b32 v68, 16, v45
    v_and_b32 v69, 0xffff0000, v45
    v_pk_add_f32 v[62:63], v[62:63], v[68:69]
    v_lshlrev_b32 v68, 16, v46
    v_and_b32 v69, 0xffff0000, v46
    v_pk_add_f32 v[64:65], v[64:65], v[68:69]
    v_lshlrev_b32 v68, 16, v47
    v_and_b32 v69, 0xffff0000, v47
    v_pk_add_f32 v[66:67], v[66:67], v[68:69]
    v_lshlrev_b32 v68, 16, v48
    v_and_b32 v69, 0xffff0000, v48
    v_pk_add_f32 v[60:61], v[60:61], v[68:69]
    v_lshlrev_b32 v68, 16, v49
    v_and_b32 v69, 0xffff0000, v49
    v_pk_add_f32 v[62:63], v[62:63], v[68:69]
    v_lshlrev_b32 v68, 16, v50
    v_and_b32 v69, 0xffff0000, v50
    v_pk_add_f32 v[64:65], v[64:65], v[68:69]
    v_lshlrev_b32 v68, 16, v51
    v_and_b32 v69, 0xffff0000, v51
    v_pk_add_f32 v[66:67], v[66:67], v[68:69]
    s_waitcnt vmcnt(0)
    v_lshlrev_b32 v68, 16, v56
    v_and_b32 v69, 0xffff0000, v56
    v_pk_add_f32 v[60:61], v[60:61], v[68:69]
    v_lshlrev_b32 v68, 16, v57
    v_and_b32 v69, 0xffff0000, v57
    v_pk_add_f32 v[62:63], v[62:63], v[68:69]
    v_lshlrev_b32 v68, 16, v58
    v_and_b32 v69, 0xffff0000, v58
    v_pk_add_f32 v[64:65], v[64:65], v[68:69]
    v_lshlrev_b32 v68, 16, v59
    v_and_b32 v69, 0xffff0000, v59
    v_pk_add_f32 v[66:67], v[66:67], v[68:69]
    v_lshlrev_b32 v68, 16, v52
    v_and_b32 v69, 0xffff0000, v52
    v_pk_add_f32 v[60:61], v[60:61], v[68:69]
    v_lshlrev_b32 v68, 16, v53
    v_and_b32 v69, 0xffff0000, v53
    v_pk_add_f32 v[62:63], v[62:63], v[68:69]
    v_lshlrev_b32 v68, 16, v54
    v_and_b32 v69, 0xffff0000, v54
    v_pk_add_f32 v[64:65], v[64:65], v[68:69]
    v_lshlrev_b32 v68, 16, v55
    v_and_b32 v69, 0xffff0000, v55
    v_pk_add_f32 v[66:67], v[66:67], v[68:69]
    v_cvt_pk_bf16_f32 v20, v60, v61
    v_cvt_pk_bf16_f32 v21, v62, v63
    v_cvt_pk_bf16_f32 v22, v64, v65
    v_cvt_pk_bf16_f32 v23, v66, v67
    buffer_store_dwordx4 v[20:23], v14, s[20:23], s33 offen
Lfrd_45:
L_exit:
    s_endpgm
L_code_end:
.section .rodata,"a"
.p2align 6
.amdhsa_kernel sequential_preLN__linear_attn_block__mixer_s_mlp__prompt_kernel
  .amdhsa_next_free_vgpr 168
  .amdhsa_next_free_sgpr 102
  .amdhsa_accum_offset 168
  .amdhsa_group_segment_fixed_size 0
  .amdhsa_kernarg_size 88
  .amdhsa_user_sgpr_count 2
  .amdhsa_user_sgpr_kernarg_segment_ptr 1
  .amdhsa_system_sgpr_workgroup_id_x 1
  .amdhsa_float_denorm_mode_32 3
.end_amdhsa_kernel
```
